```python
import torch

def _softmax(x, axis=-1):
    return torch.softmax(x, dim=axis)
def _gelu(x):
    return torch.nn.functional.gelu(x, approximate="tanh")
def _silu(x):
    return torch.nn.functional.silu(x)
def _sigmoid(x):
    return torch.sigmoid(x)
def _layernorm(x, axis=-1, eps=1e-5):
    m = x.mean(dim=axis, keepdim=True)
    v = x.var(dim=axis, keepdim=True, unbiased=False)
    return (x - m) / torch.sqrt(v + eps)
def _scatter_add(tgt, idx, src, axis=0):
    return tgt.clone().index_add_(axis, idx, src)
def _segment_sum(src, seg, n):
    out = torch.zeros((n,) + src.shape[1:], dtype=src.dtype)
    return out.index_add_(0, seg, src)
def _pad(x, pw):
    flat = tuple(v for pair in reversed(pw) for v in pair)
    return torch.nn.functional.pad(x, flat)

kernel_name = 'standalone__molecular_angular_gemnet__graph'

def setup_inputs():

    _w = (lambda a: (lambda t: t.to(torch.bfloat16) if t.is_floating_point() else t)(torch.as_tensor(a)))
    N, deg, De, L = 10000, 16, 16, 2
    E = N * deg
    T = E * deg
    NR = 8
    dist = torch.rand(E).to(float)
    angle = (torch.rand(T) * torch.pi).to(float)
    centers = torch.linspace(0.0, 1.0, NR).to(float)
    ang_freq = torch.arange(1, L + 1).to(float)
    return {
        "m": _w((lambda *s: torch.randn(*s, dtype=torch.bfloat16) * 0.05)(E, De)),
        "idx_in": _w((lambda lo, hi, *s: torch.randint(lo, hi, s))(0, E, T).to(torch.int64)),
        "idx_out": _w((lambda lo, hi, *s: torch.randint(lo, hi, s))(0, E, T).to(torch.int64)),
        "dist": _w(dist),
        "angle": _w(angle),
        "centers": _w(centers),
        "ang_freq": _w(ang_freq),
        "w_rbf": _w((lambda *s: torch.randn(*s, dtype=torch.bfloat16) * 0.2)(NR, De)),
        "w_sbf": _w((lambda *s: torch.randn(*s, dtype=torch.bfloat16) * 0.2)(NR * L, De)),
        "w_down": _w((lambda *s: torch.randn(*s, dtype=torch.bfloat16) * 0.2)(De, De)),
        "w_up": _w((lambda *s: torch.randn(*s, dtype=torch.bfloat16) * 0.2)(De, De)),
    }

def reference(m, idx_in, idx_out, dist, angle, centers, ang_freq, w_rbf, w_sbf, w_down, w_up):
    E, De = m.shape[0], m.shape[1]
    NR = centers.shape[0]
    L = ang_freq.shape[0]
    rbf = torch.exp(-10.0 * (dist[:, None] - centers[None, :]) ** 2)
    cbf = torch.cos(ang_freq[None, :] * angle[:, None])
    rbf_t = rbf[idx_out]
    sbf = torch.reshape(rbf_t[:, :, None] * cbf[:, None, :], (-1, NR * L))
    x = (m[idx_in] @ w_down) * (sbf @ w_sbf)
    agg = _segment_sum(x, idx_out, E)
    return m + (agg @ w_up) * (rbf @ w_rbf)
```

```asm
; @launch grid=(250,1,1) block=(1024,1,1) lds=162432
.amdgcn_target "amdgcn-amd-amdhsa--gfx950"
.text
.globl standalone__molecular_angular_gemnet__graph_kernel
.p2align 8
.type standalone__molecular_angular_gemnet__graph_kernel,@function
standalone__molecular_angular_gemnet__graph_kernel:
    s_cmp_ge_u32 s2, 250
    s_cbranch_scc1 K_end
    s_load_dwordx8 s[40:47], s[0:1], 0
    s_load_dwordx16 s[48:63], s[0:1], 32
    s_load_dwordx2 s[64:65], s[0:1], 104
    s_getpc_b64 s[98:99]
    v_lshlrev_b32 v120, 6, v0
    v_mov_b32 v121, s99
    v_add_co_u32 v120, vcc, s98, v120
    s_nop 1
    v_addc_co_u32 v121, vcc, 0, v121, vcc
    v_cmp_gt_u32 vcc, 171, v0
    s_and_saveexec_b64 s[88:89], vcc
    s_cbranch_execz K_nopf
    global_load_dword v122, v[120:121], off
K_nopf:
    s_mov_b64 exec, -1
    v_lshlrev_b32 v110, 4, v0
    v_lshlrev_b32 v111, 3, v0
    v_lshlrev_b32 v112, 2, v0
    v_and_b32 v1, 63, v0
    v_lshrrev_b32 v113, 6, v0
    v_mov_b32 v7, 0
    v_lshlrev_b32 v126, 4, v1
    v_readfirstlane_b32 s3, v113
    s_mul_i32 s80, s2, 40960
    s_mul_i32 s83, s2, 20480
    s_add_u32 s81, s80, 16384
    s_add_u32 s82, s80, 32768
    s_add_u32 s84, s83, 8192
    s_add_u32 s85, s83, 16384
    v_and_b32 v114, 0x3fc, v112
    ds_write_b32 v114, v7 offset:19072
    v_mov_b32 v100, 0xffffc000
    v_mov_b32 v101, 0
    ds_write_b64 v7, v[100:101] offset:2592
    ds_write_b32 v7, v7 offset:2560
    ds_write_b32 v7, v7 offset:2564
    v_mul_u32_u24 v102, 1792, v0
    v_add_u32 v102, 19072, v102
    v_add_u32 v103, 888, v102
    v_add_u32 v104, 896, v102
    v_add_u32 v105, 1784, v102
    v_cmp_gt_u32 vcc, 80, v0
    s_and_saveexec_b64 s[88:89], vcc
    ds_write_b128 v110, v[102:105] offset:0
    ds_write_b128 v110, v[102:105] offset:1280
    s_mov_b64 exec, -1
    s_and_b32 s86, s2, 7
    s_lshr_b32 s87, s2, 3
    s_mul_i32 s24, s86, 31
    s_add_u32 s24, s24, s87
    s_min_u32 s86, s86, 2
    s_add_u32 s24, s24, s86
    s_movk_i32 s94, 512
    s_cmp_eq_u32 s3, 0
    s_cselect_b32 s94, 256, s94
    s_cmp_ge_u32 s3, 4
    s_cselect_b32 s94, 320000, s94
    s_mul_i32 s97, s24, 1280
    s_lshl_b32 s86, s3, 10
    s_add_u32 s97, s97, s86
    s_sub_u32 s97, s97, 4096
    s_cmp_ge_u32 s3, 4
    s_cselect_b32 s97, s97, 0
    s_cmp_ge_u32 s3, 6
    s_cselect_b32 s94, 0, s94
    s_cselect_b32 s97, 0, s97
    s_mov_b32 s95, 0x20000
    s_waitcnt lgkmcnt(0)
    s_mov_b32 s68, s44
    s_mov_b32 s69, s45
    s_mov_b32 s70, 10240000
    s_mov_b32 s71, 0x20000
    buffer_load_dwordx4 v[64:67], v110, s[68:71], s80 offen nt
    buffer_load_dwordx4 v[68:71], v110, s[68:71], s81 offen nt
    buffer_load_dwordx2 v[72:73], v111, s[68:71], s82 offen nt
    s_cmp_eq_u32 s3, 1
    s_cselect_b64 s[92:93], s[56:57], s[54:55]
    s_cmp_eq_u32 s3, 2
    s_cselect_b64 s[92:93], s[58:59], s[92:93]
    s_cmp_eq_u32 s3, 3
    s_cselect_b64 s[92:93], s[60:61], s[92:93]
    s_cmp_ge_u32 s3, 4
    s_cselect_b64 s[92:93], s[46:47], s[92:93]
    buffer_load_dwordx4 v[20:23], v126, s[92:95], s97 offen
    s_mov_b32 s72, s42
    s_mov_b32 s73, s43
    s_mov_b32 s74, 10240000
    s_mov_b32 s75, 0x20000
    s_mov_b32 s76, s48
    s_mov_b32 s77, s49
    s_mov_b32 s78, 5120000
    s_mov_b32 s79, 0x20000
    s_barrier
    buffer_load_dwordx4 v[74:77], v110, s[72:75], s80 offen nt
    buffer_load_dwordx2 v[84:85], v111, s[76:79], s83 offen nt
    buffer_load_dwordx4 v[78:81], v110, s[72:75], s81 offen nt
    buffer_load_dwordx2 v[86:87], v111, s[76:79], s84 offen nt
    buffer_load_dwordx2 v[82:83], v111, s[72:75], s82 offen nt
    buffer_load_dword v88, v112, s[76:79], s85 offen nt
    s_load_dword s25, s[64:65], 0
    s_add_u32 s4, s64, 1048576
    s_addc_u32 s5, s65, 0
    s_mov_b32 s6, 16384000
    s_mov_b32 s7, 0x20000
    s_mov_b32 s8, s64
    s_mov_b32 s9, s65
    s_mov_b32 s10, 516096
    s_mov_b32 s11, 0x20000
    s_mov_b32 s12, s40
    s_mov_b32 s13, s41
    s_mov_b32 s14, 5120000
    s_mov_b32 s15, 0x20000
    s_mov_b32 s16, s62
    s_mov_b32 s17, s63
    s_mov_b32 s18, 5120000
    s_mov_b32 s19, 0x20000
    s_load_dwordx4 s[40:43], s[50:51], 0
    s_load_dword s44, s[52:53], 0
    s_lshl_b32 s86, s2, 16
    s_add_u32 s20, s4, s86
    s_addc_u32 s21, s5, 0
    s_mov_b32 s23, 0x20000
    s_mov_b32 s88, 6710887
    s_movk_i32 s89, 0xff60
    s_movk_i32 s90, 22144
    s_mov_b32 s91, 107374
    s_mov_b32 s33, 0xffffffe0
    s_mov_b32 s34, 0xffff0000
    s_mov_b32 s35, 162424
    s_mov_b32 s37, 5120000
    s_mov_b32 s27, 0
    s_mov_b32 s28, 0
    s_mul_i32 s32, s24, 20480
    s_mul_i32 s87, s3, 1280
    s_add_u32 s32, s32, s87
    v_mov_b32 v127, 1
    s_waitcnt vmcnt(9)
    v_mul_hi_u32_u24 v90, s88, v64
    v_mul_hi_u32_u24 v91, s88, v65
    v_mul_hi_u32_u24 v92, s88, v66
    v_mul_hi_u32_u24 v93, s88, v67
    v_lshlrev_b32 v90, 2, v90
    v_lshlrev_b32 v91, 2, v91
    v_lshlrev_b32 v92, 2, v92
    v_lshlrev_b32 v93, 2, v93
    ds_add_rtn_u32 v100, v90, v127 offset:19072
    ds_add_rtn_u32 v101, v91, v127 offset:19072
    ds_add_rtn_u32 v102, v92, v127 offset:19072
    ds_add_rtn_u32 v103, v93, v127 offset:19072
    s_waitcnt vmcnt(8)
    v_mul_hi_u32_u24 v94, s88, v68
    v_mul_hi_u32_u24 v95, s88, v69
    v_mul_hi_u32_u24 v96, s88, v70
    v_mul_hi_u32_u24 v97, s88, v71
    v_lshlrev_b32 v94, 2, v94
    v_lshlrev_b32 v95, 2, v95
    v_lshlrev_b32 v96, 2, v96
    v_lshlrev_b32 v97, 2, v97
    ds_add_rtn_u32 v104, v94, v127 offset:19072
    ds_add_rtn_u32 v105, v95, v127 offset:19072
    ds_add_rtn_u32 v106, v96, v127 offset:19072
    ds_add_rtn_u32 v107, v97, v127 offset:19072
    s_waitcnt vmcnt(7)
    v_mul_hi_u32_u24 v98, s88, v72
    v_mul_hi_u32_u24 v99, s88, v73
    v_lshlrev_b32 v98, 2, v98
    v_lshlrev_b32 v99, 2, v99
    ds_add_rtn_u32 v108, v98, v127 offset:19072
    ds_add_rtn_u32 v109, v99, v127 offset:19072
    s_waitcnt lgkmcnt(0)
    s_barrier
    s_add_u32 s25, s25, 0x9e3779b9
    s_mul_i32 s26, s25, 0x85ebca6b
    s_and_b32 s26, s26, 0xf8000000
    s_cmp_lg_u32 s3, 0
    s_cbranch_scc1 K_noscan1
    s_setprio 3
    v_lshlrev_b32 v113, 4, v1
    ds_read_b128 v[114:117], v113 offset:19072
    s_waitcnt lgkmcnt(0)
    v_add_u32 v40, 1, v114
    v_add_u32 v41, 1, v115
    v_add_u32 v42, 1, v116
    v_add_u32 v43, 1, v117
    v_lshrrev_b32 v40, 1, v40
    v_lshrrev_b32 v41, 1, v41
    v_lshrrev_b32 v42, 1, v42
    v_lshrrev_b32 v43, 1, v43
    v_add_u32 v46, v40, v41
    v_add_u32 v47, v46, v42
    v_add_u32 v45, v47, v43
    v_mov_b32 v44, v45
    s_nop 1
    v_add_u32_dpp v44, v44, v44 row_shr:1 row_mask:0xf bank_mask:0xf bound_ctrl:0
    s_nop 1
    v_add_u32_dpp v44, v44, v44 row_shr:2 row_mask:0xf bank_mask:0xf bound_ctrl:0
    s_nop 1
    v_add_u32_dpp v44, v44, v44 row_shr:4 row_mask:0xf bank_mask:0xf bound_ctrl:0
    s_nop 1
    v_add_u32_dpp v44, v44, v44 row_shr:8 row_mask:0xf bank_mask:0xf bound_ctrl:0
    s_nop 1
    v_add_u32_dpp v44, v44, v44 row_bcast:15 row_mask:0xa bank_mask:0xf
    s_nop 1
    v_add_u32_dpp v44, v44, v44 row_bcast:31 row_mask:0xc bank_mask:0xf
    v_sub_u32 v118, v44, v45
    v_add_u32 v119, v118, v40
    v_add_u32 v120, v118, v46
    v_add_u32 v121, v118, v47
    v_mad_u32_u24 v122, v118, 12, s90
    v_mad_u32_u24 v123, v119, 12, s90
    v_mad_u32_u24 v124, v120, 12, s90
    v_mad_u32_u24 v125, v121, 12, s90
    ds_write_b128 v113, v[122:125] offset:20096
    s_mov_b32 exec_lo, 0
    s_mov_b32 exec_hi, 0x80000000
    ds_write_b32 v7, v44 offset:2568
    s_mov_b64 exec, -1
    v_lshl_or_b32 v114, v114, 13, v118
    v_lshl_or_b32 v115, v115, 13, v119
    v_lshl_or_b32 v116, v116, 13, v120
    v_lshl_or_b32 v117, v117, 13, v121
    v_or_b32 v114, s26, v114
    v_or_b32 v115, s26, v115
    v_or_b32 v116, s26, v116
    v_or_b32 v117, s26, v117
    ds_write_b128 v113, v[114:117] offset:21120
    s_setprio 0
K_noscan1:
    v_mad_i32_i24 v64, v90, s89, v64
    v_mad_i32_i24 v65, v91, s89, v65
    v_mad_i32_i24 v66, v92, s89, v66
    v_mad_i32_i24 v67, v93, s89, v67
    v_mad_i32_i24 v68, v94, s89, v68
    v_mad_i32_i24 v69, v95, s89, v69
    v_mad_i32_i24 v70, v96, s89, v70
    v_mad_i32_i24 v71, v97, s89, v71
    v_mad_i32_i24 v72, v98, s89, v72
    v_mad_i32_i24 v73, v99, s89, v73
    s_movk_i32 s96, 0x802
    v_mul_u32_u24 v64, s96, v64
    v_mul_u32_u24 v65, s96, v65
    v_mul_u32_u24 v66, s96, v66
    v_mul_u32_u24 v67, s96, v67
    v_mul_u32_u24 v68, s96, v68
    v_mul_u32_u24 v69, s96, v69
    v_mul_u32_u24 v70, s96, v70
    v_mul_u32_u24 v71, s96, v71
    v_mul_u32_u24 v72, s96, v72
    v_mul_u32_u24 v73, s96, v73
    v_and_b32 v64, 0x3ff0, v64
    v_and_b32 v65, 0x3ff0, v65
    v_and_b32 v66, 0x3ff0, v66
    v_and_b32 v67, 0x3ff0, v67
    v_and_b32 v68, 0x3ff0, v68
    v_and_b32 v69, 0x3ff0, v69
    v_and_b32 v70, 0x3ff0, v70
    v_and_b32 v71, 0x3ff0, v71
    v_and_b32 v72, 0x3ff0, v72
    v_and_b32 v73, 0x3ff0, v73
    s_waitcnt lgkmcnt(0)
    s_barrier
    ds_read_b32 v90, v90 offset:20096
    ds_read_b32 v91, v91 offset:20096
    ds_read_b32 v92, v92 offset:20096
    ds_read_b32 v93, v93 offset:20096
    ds_read_b32 v94, v94 offset:20096
    ds_read_b32 v95, v95 offset:20096
    ds_read_b32 v96, v96 offset:20096
    ds_read_b32 v97, v97 offset:20096
    ds_read_b32 v98, v98 offset:20096
    ds_read_b32 v99, v99 offset:20096
    ds_read_b32 v113, v7 offset:2568
    s_waitcnt lgkmcnt(10)
    v_mad_u32_u24 v90, v100, 6, v90
    v_and_b32 v100, -4, v90
    v_xor_b32 v90, 2, v90
    s_waitcnt lgkmcnt(9)
    v_mad_u32_u24 v91, v101, 6, v91
    v_and_b32 v101, -4, v91
    v_xor_b32 v91, 2, v91
    s_waitcnt lgkmcnt(8)
    v_mad_u32_u24 v92, v102, 6, v92
    v_and_b32 v102, -4, v92
    v_xor_b32 v92, 2, v92
    s_waitcnt lgkmcnt(7)
    v_mad_u32_u24 v93, v103, 6, v93
    v_and_b32 v103, -4, v93
    v_xor_b32 v93, 2, v93
    s_waitcnt lgkmcnt(6)
    v_mad_u32_u24 v94, v104, 6, v94
    v_and_b32 v104, -4, v94
    v_xor_b32 v94, 2, v94
    s_waitcnt lgkmcnt(5)
    v_mad_u32_u24 v95, v105, 6, v95
    v_and_b32 v105, -4, v95
    v_xor_b32 v95, 2, v95
    s_waitcnt lgkmcnt(4)
    v_mad_u32_u24 v96, v106, 6, v96
    v_and_b32 v106, -4, v96
    v_xor_b32 v96, 2, v96
    s_waitcnt lgkmcnt(3)
    v_mad_u32_u24 v97, v107, 6, v97
    v_and_b32 v107, -4, v97
    v_xor_b32 v97, 2, v97
    s_waitcnt lgkmcnt(2)
    v_mad_u32_u24 v98, v108, 6, v98
    v_and_b32 v108, -4, v98
    v_xor_b32 v98, 2, v98
    s_waitcnt lgkmcnt(1)
    v_mad_u32_u24 v99, v109, 6, v99
    v_and_b32 v109, -4, v99
    v_xor_b32 v99, 2, v99
    s_waitcnt lgkmcnt(0)
    v_readfirstlane_b32 s92, v113
    s_waitcnt vmcnt(5)
    s_cmp_ge_u32 s3, 6
    s_cbranch_scc1 K_nostage
    s_lshl_b32 s93, s3, 10
    v_lshl_add_u32 v114, v1, 4, s93
    v_add_u32 v114, 68224, v114
    ds_write_b128 v114, v[20:23] offset:32768
K_nostage:
    v_mul_hi_u32_u24 v114, s91, v74
    v_mul_hi_u32_u24 v115, s91, v75
    v_mul_hi_u32_u24 v116, s91, v76
    v_mul_hi_u32_u24 v117, s91, v77
    v_lshl_or_b32 v74, v74, 14, v64
    v_lshl_or_b32 v75, v75, 14, v65
    v_lshl_or_b32 v76, v76, 14, v66
    v_lshl_or_b32 v77, v77, 14, v67
    v_lshl_or_b32 v74, v114, 2, v74
    v_lshl_or_b32 v75, v115, 2, v75
    v_lshl_or_b32 v76, v116, 2, v76
    v_lshl_or_b32 v77, v117, 2, v77
    ds_write_b32 v100, v74
    ds_write_b32 v101, v75
    ds_write_b32 v102, v76
    ds_write_b32 v103, v77
    s_waitcnt vmcnt(4)
    ds_write_b16 v90, v84 offset:6
    ds_write_b16_d16_hi v91, v84 offset:6
    ds_write_b16 v92, v85 offset:6
    ds_write_b16_d16_hi v93, v85 offset:6
    s_waitcnt vmcnt(3)
    v_mul_hi_u32_u24 v114, s91, v78
    v_mul_hi_u32_u24 v115, s91, v79
    v_mul_hi_u32_u24 v116, s91, v80
    v_mul_hi_u32_u24 v117, s91, v81
    v_lshl_or_b32 v78, v78, 14, v68
    v_lshl_or_b32 v79, v79, 14, v69
    v_lshl_or_b32 v80, v80, 14, v70
    v_lshl_or_b32 v81, v81, 14, v71
    v_lshl_or_b32 v78, v114, 2, v78
    v_lshl_or_b32 v79, v115, 2, v79
    v_lshl_or_b32 v80, v116, 2, v80
    v_lshl_or_b32 v81, v117, 2, v81
    ds_write_b32 v104, v78
    ds_write_b32 v105, v79
    ds_write_b32 v106, v80
    ds_write_b32 v107, v81
    s_waitcnt vmcnt(2)
    ds_write_b16 v94, v86 offset:6
    ds_write_b16_d16_hi v95, v86 offset:6
    ds_write_b16 v96, v87 offset:6
    ds_write_b16_d16_hi v97, v87 offset:6
    s_waitcnt vmcnt(1)
    v_mul_hi_u32_u24 v114, s91, v82
    v_mul_hi_u32_u24 v115, s91, v83
    v_lshl_or_b32 v82, v82, 14, v72
    v_lshl_or_b32 v83, v83, 14, v73
    v_lshl_or_b32 v82, v114, 2, v82
    v_lshl_or_b32 v83, v115, 2, v83
    ds_write_b32 v108, v82
    ds_write_b32 v109, v83
    s_waitcnt vmcnt(0)
    ds_write_b16 v98, v88 offset:6
    ds_write_b16_d16_hi v99, v88 offset:6
    s_mul_i32 s22, s92, 12
    s_add_u32 s22, s22, 15
    s_and_b32 s22, s22, 0xfffffff0
    v_add_u32 v111, 22144, v110
    v_lshlrev_b32 v88, 3, v1
    s_waitcnt lgkmcnt(0)
    s_setprio 3
    s_barrier
    ds_read_b128 v[64:67], v111 offset:0
    ds_read_b128 v[68:71], v111 offset:16384
    ds_read_b128 v[72:75], v111 offset:32768
    ds_read_b128 v[76:79], v111 offset:49152
    ds_read_b64 v[90:91], v88 offset:21120
    ds_read_b64 v[92:93], v88 offset:21632
    s_waitcnt lgkmcnt(5)
    buffer_store_dwordx4 v[64:67], v110, s[20:23], 0 offen sc1
    s_waitcnt lgkmcnt(4)
    s_mov_b32 s92, 16384
    buffer_store_dwordx4 v[68:71], v110, s[20:23], s92 offen sc1
    s_waitcnt lgkmcnt(3)
    s_mov_b32 s92, 32768
    buffer_store_dwordx4 v[72:75], v110, s[20:23], s92 offen sc1
    s_waitcnt lgkmcnt(2)
    s_mov_b32 s92, 49152
    buffer_store_dwordx4 v[76:79], v110, s[20:23], s92 offen sc1
    s_setprio 0
    s_waitcnt lgkmcnt(0)
    v_mov_b32 v80, v90
    v_mov_b32 v81, s25
    v_mov_b32 v82, v91
    v_mov_b32 v83, s25
    v_mov_b32 v84, v92
    v_mov_b32 v85, s25
    v_mov_b32 v86, v93
    v_mov_b32 v87, s25
    v_lshlrev_b32 v88, 4, v1
    v_lshrrev_b32 v94, 4, v1
    v_and_b32 v95, 15, v1
    v_lshrrev_b32 v117, 1, v95
    v_lshlrev_b32 v118, 3, v94
    v_add_u32 v118, 100992, v118
    v_lshl_add_u32 v115, v95, 5, v118
    v_lshl_add_u32 v116, v117, 5, v118
    v_and_b32 v114, 3, v95
    v_and_b32 v112, 4, v95
    v_lshl_add_u32 v114, v112, 1, v114
    v_lshl_add_u32 v114, v114, 5, v118
    ds_read_b64 v[20:21], v114 offset:2048
    ds_read_b64 v[22:23], v114 offset:2176
    ds_read_b64 v[14:15], v115 offset:1024
    ds_read_b64 v[16:17], v115 offset:3072
    ds_read_b64 v[18:19], v116
    s_mul_i32 s87, s3, 80
    s_add_u32 s87, s87, 105088
    v_lshl_add_u32 v112, v117, 1, s87
    ds_read_u16 v101, v112 offset:0
    ds_read_u16 v102, v112 offset:16
    ds_read_u16 v103, v112 offset:32
    ds_read_u16 v104, v112 offset:48
    ds_read_u16 v105, v112 offset:64
    s_waitcnt vmcnt(0) lgkmcnt(0)
    s_barrier
    s_cmp_lg_u32 s3, 0
    s_cbranch_scc1 K_nopub
    s_lshl_b32 s82, s2, 11
    s_add_u32 s82, s82, 4096
    buffer_store_dwordx4 v[80:83], v88, s[8:11], s82 offen sc1
    buffer_store_dwordx4 v[84:87], v88, s[8:11], s82 offen offset:1024 sc1
K_nopub:
    v_lshrrev_b32 v94, 4, v1
    v_and_b32 v95, 15, v1
    v_and_b32 v96, 1, v94
    v_lshlrev_b32 v2, 4, v96
    v_lshrrev_b32 v97, 1, v94
    v_lshl_add_u32 v97, v97, 4, v95
    v_lshlrev_b32 v3, 3, v97
    v_lshrrev_b32 v97, 2, v95
    v_lshlrev_b32 v97, 4, v97
    v_and_b32 v4, 3, v95
    v_lshl_add_u32 v97, v4, 1, v97
    v_lshrrev_b32 v4, 1, v94
    v_lshl_add_u32 v97, v4, 3, v97
    v_lshl_add_u32 v97, v96, 6, v97
    s_lshl_b32 s86, s3, 10
    s_add_u32 s86, s86, 2688
    v_add_u32 v4, s86, v97
    v_lshlrev_b32 v97, 6, v95
    v_lshl_add_u32 v97, v94, 4, v97
    v_add_u32 v5, s86, v97
    v_lshrrev_b32 v96, 1, v95
    v_lshlrev_b32 v97, 5, v96
    v_lshl_add_u32 v52, v94, 3, v97
    v_mov_b32 v108, 0
    v_mov_b32 v109, 0
    v_mov_b32 v110, 0
    v_mov_b32 v111, 0
    v_lshlrev_b32 v97, 4, v1
    v_add_u32 v97, s86, v97
    ds_write_b128 v97, v[108:111]
    v_mov_b32 v8, s40
    v_cmp_eq_u32 vcc, 1, v94
    v_mov_b32 v112, s41
    v_cndmask_b32 v8, v8, v112, vcc
    v_cmp_eq_u32 vcc, 2, v94
    v_mov_b32 v112, s42
    v_cndmask_b32 v8, v8, v112, vcc
    v_cmp_eq_u32 vcc, 3, v94
    v_mov_b32 v112, s43
    v_cndmask_b32 v8, v8, v112, vcc
    v_and_b32 v112, 1, v94
    v_lshlrev_b32 v112, 4, v112
    v_lshrrev_b32 v6, v112, s44
    s_waitcnt lgkmcnt(0)
    v_lshlrev_b32 v97, 1, v94
    v_and_b32 v98, 1, v1
    v_lshlrev_b32 v98, 4, v98
    v_mov_b32 v113, 0x3f80
    v_lshlrev_b32 v112, v98, v113
    v_cmp_eq_u32 vcc, v96, v97
    v_add_u32 v97, 1, v97
    v_lshlrev_b32 v113, 2, v96
    v_cndmask_b32 v106, v7, v112, vcc
    v_cmp_eq_u32 vcc, v96, v97
    s_nop 1
    v_cndmask_b32 v107, v7, v112, vcc
    s_nop 1
    v_mfma_f32_16x16x16_bf16 v[28:31], v[20:21], v[106:107], 0
    v_mfma_f32_16x16x16_bf16 v[32:35], v[22:23], v[106:107], 0
    v_mfma_f32_16x16x16_bf16 v[36:39], v[14:15], v[106:107], 0
    v_mfma_f32_16x16x16_bf16 v[40:43], v[16:17], v[106:107], 0
    v_mfma_f32_16x16x16_bf16 v[44:47], v[18:19], v[106:107], 0
    v_cmp_gt_u32 vcc, 32, v1
    v_and_b32 v11, s34, v8
    v_lshlrev_b32 v9, 16, v8
    v_lshlrev_b32 v6, 16, v6
    v_mul_f32 v6, 0.15915494, v6
    v_mov_b32 v12, 0
    v_lshlrev_b32 v89, 14, v1
    s_and_b32 s80, s3, 1
    s_lshl_b32 s80, s80, 18
    s_lshr_b32 s81, s3, 1
    s_lshl_b32 s81, s81, 11
    s_add_u32 s80, s80, s81
    s_lshl_b32 s81, s24, 3
    s_add_u32 s80, s80, s81
    s_add_u32 s80, s80, 4096
    s_and_b32 s81, s3, 1
    s_cmp_ge_u32 s3, 5
    s_cselect_b32 s81, s81, 0
    s_sub_u32 s81, 16, s81
    s_bfm_b32 s39, s81, 0
    v_cvt_pk_bf16_f32 v20, v28, v29
    v_cvt_pk_bf16_f32 v21, v30, v31
    v_cvt_pk_bf16_f32 v22, v32, v33
    v_cvt_pk_bf16_f32 v23, v34, v35
    v_cvt_pk_bf16_f32 v14, v36, v37
    v_cvt_pk_bf16_f32 v15, v38, v39
    v_cvt_pk_bf16_f32 v16, v40, v41
    v_cvt_pk_bf16_f32 v17, v42, v43
    v_cvt_pk_bf16_f32 v18, v44, v45
    v_cvt_pk_bf16_f32 v19, v46, v47
    v_cndmask_b32 v24, v20, v7, vcc
    v_cndmask_b32 v25, v21, v7, vcc
    v_cndmask_b32 v26, v22, v7, vcc
    v_cndmask_b32 v27, v23, v7, vcc
    v_cndmask_b32 v20, v7, v20, vcc
    v_cndmask_b32 v21, v7, v21, vcc
    v_cndmask_b32 v22, v7, v22, vcc
    v_cndmask_b32 v23, v7, v23, vcc
    v_mov_b32 v28, 0
    v_mov_b32 v29, 0
    v_mov_b32 v30, 0
    v_mov_b32 v31, 0
    v_mov_b32 v32, 0
    v_mov_b32 v33, 0
    v_mov_b32 v34, 0
    v_mov_b32 v35, 0
    v_mov_b32 v36, 0
    v_mov_b32 v37, 0
    v_mov_b32 v38, 0
    v_mov_b32 v39, 0
    v_mov_b32 v40, 0
    v_mov_b32 v41, 0
    v_mov_b32 v42, 0
    v_mov_b32 v43, 0
    v_mov_b32 v44, 0
    v_mov_b32 v45, 0
    v_mov_b32 v46, 0
    v_mov_b32 v47, 0
    s_waitcnt lgkmcnt(0)
    v_lshlrev_b32 v8, 16, v101
    v_lshlrev_b32 v10, 16, v102
    v_lshlrev_b32 v48, 16, v103
    v_lshlrev_b32 v50, 16, v104
    v_lshlrev_b32 v124, 16, v105
    v_lshrrev_b32 v113, 5, v1
    v_and_b32 v115, 31, v1
    v_lshlrev_b32 v118, 2, v113
    v_add_u32 v115, s28, v115
    v_mul_u32_u24 v114, 12, v115
    v_lshlrev_b32 v115, 1, v115
    v_lshl_add_u32 v114, v113, 19, v114
    v_add_u32 v116, 1, v115
    s_mov_b32 s83, 0
    s_mov_b32 exec_lo, s39
    s_mov_b32 exec_hi, 0
K_poll:
    buffer_load_dwordx2 v[90:91], v89, s[8:11], s80 offen sc1
K_poll_w:
    s_waitcnt vmcnt(0)
K_poll_c:
    v_cmp_ne_u32 vcc, s25, v91
    v_and_b32 v91, 0xf8000000, v90
    v_cmp_ne_u32_e64 s[84:85], s26, v91
    s_or_b64 s[84:85], vcc, s[84:85]
    s_cbranch_scc0 K_polled
    s_sleep 2
    s_add_u32 s83, s83, 1
    s_cmp_lt_u32 s83, 40000
    s_cbranch_scc1 K_poll
    s_mov_b64 exec, -1
    s_branch K_end
K_polled:
    s_setprio 2
    v_and_b32 v12, 0x7ffffff, v90
    s_mov_b64 exec, -1
K_polled3:
    v_and_b32 v119, 0x1fff, v12
    v_lshrrev_b32 v112, 13, v12
    v_mul_u32_u24 v119, 12, v119
    v_lshl_or_b32 v12, v112, 16, v119
    s_mov_b64 exec, 0xffff
    ds_max_u32 v7, v112 offset:2564
    s_mov_b64 exec, -1
    v_cmp_lt_u32 vcc, 64, v112
    s_mov_b32 s36, 0
    s_cmp_lg_u64 vcc, 0
    s_cselect_b32 s36, 1, 0
K_round:
    s_cmp_eq_u32 s36, 0
    s_cbranch_scc1 K_nox
    v_lshrrev_b32 v119, 3, v1
    v_lshlrev_b32 v120, 2, v119
    ds_bpermute_b32 v104, v120, v12 offset:0
    ds_bpermute_b32 v105, v120, v12 offset:32
    v_and_b32 v121, 7, v1
    v_add_u32 v121, 32, v121
    v_mul_u32_u24 v122, 12, v121
    v_lshl_add_u32 v122, v119, 19, v122
    v_lshlrev_b32 v121, 1, v121
    v_add_u32 v123, 1, v121
    s_and_b32 s80, s3, 1
    s_lshl_b32 s80, s80, 23
    s_lshr_b32 s81, s3, 1
    s_lshl_b32 s81, s81, 16
    s_add_u32 s80, s80, s81
    s_waitcnt lgkmcnt(0)
    v_cmp_gt_i32_sdwa s[72:73], v104, v121 src0_sel:WORD_1 src1_sel:DWORD
    v_cmp_gt_i32_sdwa s[74:75], v104, v123 src0_sel:WORD_1 src1_sel:DWORD
    v_add_u32_sdwa v104, v104, v122 dst_sel:DWORD dst_unused:UNUSED_PAD src0_sel:WORD_0 src1_sel:DWORD
    s_or_b64 exec, s[72:73], 1
    buffer_load_dwordx3 v[96:98], v104, s[4:7], s80 offen sc1
    s_mov_b64 exec, -1
    s_add_u32 s80, s80, 4194304
    v_cmp_gt_i32_sdwa s[76:77], v105, v121 src0_sel:WORD_1 src1_sel:DWORD
    v_cmp_gt_i32_sdwa s[78:79], v105, v123 src0_sel:WORD_1 src1_sel:DWORD
    v_add_u32_sdwa v105, v105, v122 dst_sel:DWORD dst_unused:UNUSED_PAD src0_sel:WORD_0 src1_sel:DWORD
    s_or_b64 exec, s[76:77], 1
    buffer_load_dwordx3 v[100:102], v105, s[4:7], s80 offen sc1
    s_mov_b64 exec, -1
    s_add_u32 s80, s80, 4194304
K_nox:
    ds_bpermute_b32 v104, v118, v12 offset:0
    ds_bpermute_b32 v105, v118, v12 offset:8
    ds_bpermute_b32 v106, v118, v12 offset:16
    ds_bpermute_b32 v107, v118, v12 offset:24
    ds_bpermute_b32 v108, v118, v12 offset:32
    ds_bpermute_b32 v109, v118, v12 offset:40
    ds_bpermute_b32 v110, v118, v12 offset:48
    ds_bpermute_b32 v111, v118, v12 offset:56
    s_and_b32 s80, s3, 1
    s_lshl_b32 s80, s80, 23
    s_lshr_b32 s81, s3, 1
    s_lshl_b32 s81, s81, 16
    s_add_u32 s80, s80, s81
    s_waitcnt lgkmcnt(7)
    v_cmp_gt_i32_sdwa s[40:41], v104, v115 src0_sel:WORD_1 src1_sel:DWORD
    v_cmp_gt_i32_sdwa s[42:43], v104, v116 src0_sel:WORD_1 src1_sel:DWORD
    v_add_u32_sdwa v104, v104, v114 dst_sel:DWORD dst_unused:UNUSED_PAD src0_sel:WORD_0 src1_sel:DWORD
    s_waitcnt lgkmcnt(6)
    v_cmp_gt_i32_sdwa s[44:45], v105, v115 src0_sel:WORD_1 src1_sel:DWORD
    v_cmp_gt_i32_sdwa s[46:47], v105, v116 src0_sel:WORD_1 src1_sel:DWORD
    v_add_u32_sdwa v105, v105, v114 dst_sel:DWORD dst_unused:UNUSED_PAD src0_sel:WORD_0 src1_sel:DWORD
    s_or_b64 exec, s[40:41], 1
    buffer_load_dwordx3 v[64:66], v104, s[4:7], s80 offen sc1
    s_mov_b64 exec, -1
    s_add_u32 s80, s80, 1048576
    s_waitcnt lgkmcnt(5)
    v_cmp_gt_i32_sdwa s[48:49], v106, v115 src0_sel:WORD_1 src1_sel:DWORD
    v_cmp_gt_i32_sdwa s[50:51], v106, v116 src0_sel:WORD_1 src1_sel:DWORD
    v_add_u32_sdwa v106, v106, v114 dst_sel:DWORD dst_unused:UNUSED_PAD src0_sel:WORD_0 src1_sel:DWORD
    s_or_b64 exec, s[44:45], 1
    buffer_load_dwordx3 v[68:70], v105, s[4:7], s80 offen sc1
    s_mov_b64 exec, -1
    s_add_u32 s80, s80, 1048576
    s_waitcnt lgkmcnt(4)
    v_cmp_gt_i32_sdwa s[52:53], v107, v115 src0_sel:WORD_1 src1_sel:DWORD
    v_cmp_gt_i32_sdwa s[54:55], v107, v116 src0_sel:WORD_1 src1_sel:DWORD
    v_add_u32_sdwa v107, v107, v114 dst_sel:DWORD dst_unused:UNUSED_PAD src0_sel:WORD_0 src1_sel:DWORD
    s_or_b64 exec, s[48:49], 1
    buffer_load_dwordx3 v[72:74], v106, s[4:7], s80 offen sc1
    s_mov_b64 exec, -1
    s_add_u32 s80, s80, 1048576
    s_waitcnt lgkmcnt(3)
    v_cmp_gt_i32_sdwa s[56:57], v108, v115 src0_sel:WORD_1 src1_sel:DWORD
    v_cmp_gt_i32_sdwa s[58:59], v108, v116 src0_sel:WORD_1 src1_sel:DWORD
    v_add_u32_sdwa v108, v108, v114 dst_sel:DWORD dst_unused:UNUSED_PAD src0_sel:WORD_0 src1_sel:DWORD
    s_or_b64 exec, s[52:53], 1
    buffer_load_dwordx3 v[76:78], v107, s[4:7], s80 offen sc1
    s_mov_b64 exec, -1
    s_add_u32 s80, s80, 1048576
    s_waitcnt lgkmcnt(2)
    v_cmp_gt_i32_sdwa s[60:61], v109, v115 src0_sel:WORD_1 src1_sel:DWORD
    v_cmp_gt_i32_sdwa s[62:63], v109, v116 src0_sel:WORD_1 src1_sel:DWORD
    v_add_u32_sdwa v109, v109, v114 dst_sel:DWORD dst_unused:UNUSED_PAD src0_sel:WORD_0 src1_sel:DWORD
    s_or_b64 exec, s[56:57], 1
    buffer_load_dwordx3 v[80:82], v108, s[4:7], s80 offen sc1
    s_mov_b64 exec, -1
    s_add_u32 s80, s80, 1048576
    s_waitcnt lgkmcnt(1)
    v_cmp_gt_i32_sdwa s[64:65], v110, v115 src0_sel:WORD_1 src1_sel:DWORD
    v_cmp_gt_i32_sdwa s[66:67], v110, v116 src0_sel:WORD_1 src1_sel:DWORD
    v_add_u32_sdwa v110, v110, v114 dst_sel:DWORD dst_unused:UNUSED_PAD src0_sel:WORD_0 src1_sel:DWORD
    s_or_b64 exec, s[60:61], 1
    buffer_load_dwordx3 v[84:86], v109, s[4:7], s80 offen sc1
    s_mov_b64 exec, -1
    s_add_u32 s80, s80, 1048576
    s_waitcnt lgkmcnt(0)
    v_cmp_gt_i32_sdwa s[68:69], v111, v115 src0_sel:WORD_1 src1_sel:DWORD
    v_cmp_gt_i32_sdwa s[70:71], v111, v116 src0_sel:WORD_1 src1_sel:DWORD
    v_add_u32_sdwa v111, v111, v114 dst_sel:DWORD dst_unused:UNUSED_PAD src0_sel:WORD_0 src1_sel:DWORD
    s_or_b64 exec, s[64:65], 1
    buffer_load_dwordx3 v[88:90], v110, s[4:7], s80 offen sc1
    s_mov_b64 exec, -1
    s_add_u32 s80, s80, 1048576
    s_or_b64 exec, s[68:69], 1
    buffer_load_dwordx3 v[92:94], v111, s[4:7], s80 offen sc1
    s_mov_b64 exec, -1
    s_setprio 0
    v_mov_b32 v126, 19072
    s_cmp_eq_u32 s27, 0
    s_cbranch_scc1 K_pass2
    s_waitcnt vmcnt(0)
    v_mov_b32 v122, 1
    s_mov_b64 exec, s[40:41]
    v_and_b32 v120, 0x7fc, v64
    ds_add_u32 v120, v122 offset:0
    s_mov_b64 exec, s[42:43]
    v_and_b32 v121, 0x7fc, v65
    ds_add_u32 v121, v122 offset:0
    s_mov_b64 exec, s[44:45]
    v_and_b32 v120, 0x7fc, v68
    ds_add_u32 v120, v122 offset:0
    s_mov_b64 exec, s[46:47]
    v_and_b32 v121, 0x7fc, v69
    ds_add_u32 v121, v122 offset:0
    s_mov_b64 exec, s[48:49]
    v_and_b32 v120, 0x7fc, v72
    ds_add_u32 v120, v122 offset:0
    s_mov_b64 exec, s[50:51]
    v_and_b32 v121, 0x7fc, v73
    ds_add_u32 v121, v122 offset:0
    s_mov_b64 exec, s[52:53]
    v_and_b32 v120, 0x7fc, v76
    ds_add_u32 v120, v122 offset:0
    s_mov_b64 exec, s[54:55]
    v_and_b32 v121, 0x7fc, v77
    ds_add_u32 v121, v122 offset:0
    s_mov_b64 exec, s[56:57]
    v_and_b32 v120, 0x7fc, v80
    ds_add_u32 v120, v122 offset:0
    s_mov_b64 exec, s[58:59]
    v_and_b32 v121, 0x7fc, v81
    ds_add_u32 v121, v122 offset:0
    s_mov_b64 exec, s[60:61]
    v_and_b32 v120, 0x7fc, v84
    ds_add_u32 v120, v122 offset:0
    s_mov_b64 exec, s[62:63]
    v_and_b32 v121, 0x7fc, v85
    ds_add_u32 v121, v122 offset:0
    s_mov_b64 exec, s[64:65]
    v_and_b32 v120, 0x7fc, v88
    ds_add_u32 v120, v122 offset:0
    s_mov_b64 exec, s[66:67]
    v_and_b32 v121, 0x7fc, v89
    ds_add_u32 v121, v122 offset:0
    s_mov_b64 exec, s[68:69]
    v_and_b32 v120, 0x7fc, v92
    ds_add_u32 v120, v122 offset:0
    s_mov_b64 exec, s[70:71]
    v_and_b32 v121, 0x7fc, v93
    ds_add_u32 v121, v122 offset:0
    s_mov_b64 exec, -1
    s_waitcnt lgkmcnt(0)
    s_barrier
    s_cmp_lg_u32 s3, 0
    s_cbranch_scc1 K_noscan
    v_lshlrev_b32 v104, 5, v1
    v_cmp_gt_u32 vcc, 40, v1
    v_mov_b32 v96, 0
    v_mov_b32 v97, 0
    v_mov_b32 v98, 0
    v_mov_b32 v99, 0
    v_mov_b32 v100, 0
    v_mov_b32 v101, 0
    v_mov_b32 v102, 0
    v_mov_b32 v103, 0
    s_mov_b64 exec, vcc
    ds_read_b128 v[96:99], v104 offset:0
    ds_read_b128 v[100:103], v104 offset:16
    s_mov_b64 exec, -1
    s_waitcnt lgkmcnt(0)
    v_add_u32 v105, v96, v97
    v_add_u32 v105, v105, v98
    v_add_u32 v105, v105, v99
    v_add_u32 v105, v105, v100
    v_add_u32 v105, v105, v101
    v_add_u32 v105, v105, v102
    v_add_u32 v105, v105, v103
    v_mov_b32 v106, v105
    s_nop 1
    v_add_u32_dpp v106, v106, v106 row_shr:1 row_mask:0xf bank_mask:0xf bound_ctrl:0
    s_nop 1
    v_add_u32_dpp v106, v106, v106 row_shr:2 row_mask:0xf bank_mask:0xf bound_ctrl:0
    s_nop 1
    v_add_u32_dpp v106, v106, v106 row_shr:4 row_mask:0xf bank_mask:0xf bound_ctrl:0
    s_nop 1
    v_add_u32_dpp v106, v106, v106 row_shr:8 row_mask:0xf bank_mask:0xf bound_ctrl:0
    s_nop 1
    v_add_u32_dpp v106, v106, v106 row_bcast:15 row_mask:0xa bank_mask:0xf
    s_nop 1
    v_add_u32_dpp v106, v106, v106 row_bcast:31 row_mask:0xc bank_mask:0xf
    v_sub_u32 v106, v106, v105
    v_lshlrev_b32 v106, 3, v106
    v_add_u32 v106, 19072, v106
    s_mov_b64 exec, vcc
    v_mov_b32 v108, v106
    v_add_u32 v105, v96, v97
    v_lshl_add_u32 v110, v105, 3, v106
    v_add_u32 v109, -8, v110
    v_add_u32 v105, v98, v99
    v_lshl_add_u32 v106, v105, 3, v110
    v_add_u32 v111, -8, v106
    ds_write_b128 v104, v[108:111] offset:0
    ds_write_b128 v104, v[108:111] offset:1280
    s_nop 1
    v_mov_b32 v108, v106
    v_add_u32 v105, v100, v101
    v_lshl_add_u32 v110, v105, 3, v106
    v_add_u32 v109, -8, v110
    v_add_u32 v105, v102, v103
    v_lshl_add_u32 v106, v105, 3, v110
    v_add_u32 v111, -8, v106
    ds_write_b128 v104, v[108:111] offset:16
    ds_write_b128 v104, v[108:111] offset:1296
    s_nop 1
    s_mov_b64 exec, -1
    s_waitcnt lgkmcnt(0)
K_noscan:
    s_barrier
K_pass2:
    s_waitcnt vmcnt(7)
    v_and_b32 v120, 0x7fc, v64
    v_bfe_i32 v122, v64, 2, 1
    v_lshl_add_u32 v122, v122, 4, 8
    s_mov_b64 exec, s[40:41]
    ds_add_rtn_u32 v112, v120, v122 offset:0
    s_mov_b64 exec, -1
    v_and_b32 v121, 0x7fc, v65
    v_bfe_i32 v123, v65, 2, 1
    v_lshl_add_u32 v123, v123, 4, 8
    s_mov_b64 exec, s[42:43]
    ds_add_rtn_u32 v113, v121, v123 offset:0
    s_mov_b64 exec, -1
    s_waitcnt vmcnt(6)
    v_and_b32 v120, 0x7fc, v68
    v_bfe_i32 v122, v68, 2, 1
    v_lshl_add_u32 v122, v122, 4, 8
    s_mov_b64 exec, s[44:45]
    ds_add_rtn_u32 v114, v120, v122 offset:0
    s_mov_b64 exec, -1
    v_and_b32 v121, 0x7fc, v69
    v_bfe_i32 v123, v69, 2, 1
    v_lshl_add_u32 v123, v123, 4, 8
    s_mov_b64 exec, s[46:47]
    ds_add_rtn_u32 v115, v121, v123 offset:0
    s_mov_b64 exec, -1
    s_waitcnt lgkmcnt(0)
    v_med3_i32 v112, v112, v126, s35
    v_lshlrev_b32 v67, 16, v66
    s_mov_b64 exec, s[40:41]
    ds_write2_b32 v112, v64, v67 offset0:0 offset1:1
    s_mov_b64 exec, -1
    v_med3_i32 v113, v113, v126, s35
    v_and_b32 v66, s34, v66
    s_mov_b64 exec, s[42:43]
    ds_write2_b32 v113, v65, v66 offset0:0 offset1:1
    s_mov_b64 exec, -1
    v_med3_i32 v114, v114, v126, s35
    v_lshlrev_b32 v71, 16, v70
    s_mov_b64 exec, s[44:45]
    ds_write2_b32 v114, v68, v71 offset0:0 offset1:1
    s_mov_b64 exec, -1
    v_med3_i32 v115, v115, v126, s35
    v_and_b32 v70, s34, v70
    s_mov_b64 exec, s[46:47]
    ds_write2_b32 v115, v69, v70 offset0:0 offset1:1
    s_mov_b64 exec, -1
    s_waitcnt vmcnt(5)
    v_and_b32 v120, 0x7fc, v72
    v_bfe_i32 v122, v72, 2, 1
    v_lshl_add_u32 v122, v122, 4, 8
    s_mov_b64 exec, s[48:49]
    ds_add_rtn_u32 v112, v120, v122 offset:0
    s_mov_b64 exec, -1
    v_and_b32 v121, 0x7fc, v73
    v_bfe_i32 v123, v73, 2, 1
    v_lshl_add_u32 v123, v123, 4, 8
    s_mov_b64 exec, s[50:51]
    ds_add_rtn_u32 v113, v121, v123 offset:0
    s_mov_b64 exec, -1
    s_waitcnt vmcnt(4)
    v_and_b32 v120, 0x7fc, v76
    v_bfe_i32 v122, v76, 2, 1
    v_lshl_add_u32 v122, v122, 4, 8
    s_mov_b64 exec, s[52:53]
    ds_add_rtn_u32 v114, v120, v122 offset:0
    s_mov_b64 exec, -1
    v_and_b32 v121, 0x7fc, v77
    v_bfe_i32 v123, v77, 2, 1
    v_lshl_add_u32 v123, v123, 4, 8
    s_mov_b64 exec, s[54:55]
    ds_add_rtn_u32 v115, v121, v123 offset:0
    s_mov_b64 exec, -1
    s_waitcnt lgkmcnt(0)
    v_med3_i32 v112, v112, v126, s35
    v_lshlrev_b32 v75, 16, v74
    s_mov_b64 exec, s[48:49]
    ds_write2_b32 v112, v72, v75 offset0:0 offset1:1
    s_mov_b64 exec, -1
    v_med3_i32 v113, v113, v126, s35
    v_and_b32 v74, s34, v74
    s_mov_b64 exec, s[50:51]
    ds_write2_b32 v113, v73, v74 offset0:0 offset1:1
    s_mov_b64 exec, -1
    v_med3_i32 v114, v114, v126, s35
    v_lshlrev_b32 v79, 16, v78
    s_mov_b64 exec, s[52:53]
    ds_write2_b32 v114, v76, v79 offset0:0 offset1:1
    s_mov_b64 exec, -1
    v_med3_i32 v115, v115, v126, s35
    v_and_b32 v78, s34, v78
    s_mov_b64 exec, s[54:55]
    ds_write2_b32 v115, v77, v78 offset0:0 offset1:1
    s_mov_b64 exec, -1
    s_waitcnt vmcnt(3)
    v_and_b32 v120, 0x7fc, v80
    v_bfe_i32 v122, v80, 2, 1
    v_lshl_add_u32 v122, v122, 4, 8
    s_mov_b64 exec, s[56:57]
    ds_add_rtn_u32 v112, v120, v122 offset:0
    s_mov_b64 exec, -1
    v_and_b32 v121, 0x7fc, v81
    v_bfe_i32 v123, v81, 2, 1
    v_lshl_add_u32 v123, v123, 4, 8
    s_mov_b64 exec, s[58:59]
    ds_add_rtn_u32 v113, v121, v123 offset:0
    s_mov_b64 exec, -1
    s_waitcnt vmcnt(2)
    v_and_b32 v120, 0x7fc, v84
    v_bfe_i32 v122, v84, 2, 1
    v_lshl_add_u32 v122, v122, 4, 8
    s_mov_b64 exec, s[60:61]
    ds_add_rtn_u32 v114, v120, v122 offset:0
    s_mov_b64 exec, -1
    v_and_b32 v121, 0x7fc, v85
    v_bfe_i32 v123, v85, 2, 1
    v_lshl_add_u32 v123, v123, 4, 8
    s_mov_b64 exec, s[62:63]
    ds_add_rtn_u32 v115, v121, v123 offset:0
    s_mov_b64 exec, -1
    s_waitcnt lgkmcnt(0)
    v_med3_i32 v112, v112, v126, s35
    v_lshlrev_b32 v83, 16, v82
    s_mov_b64 exec, s[56:57]
    ds_write2_b32 v112, v80, v83 offset0:0 offset1:1
    s_mov_b64 exec, -1
    v_med3_i32 v113, v113, v126, s35
    v_and_b32 v82, s34, v82
    s_mov_b64 exec, s[58:59]
    ds_write2_b32 v113, v81, v82 offset0:0 offset1:1
    s_mov_b64 exec, -1
    v_med3_i32 v114, v114, v126, s35
    v_lshlrev_b32 v87, 16, v86
    s_mov_b64 exec, s[60:61]
    ds_write2_b32 v114, v84, v87 offset0:0 offset1:1
    s_mov_b64 exec, -1
    v_med3_i32 v115, v115, v126, s35
    v_and_b32 v86, s34, v86
    s_mov_b64 exec, s[62:63]
    ds_write2_b32 v115, v85, v86 offset0:0 offset1:1
    s_mov_b64 exec, -1
    s_waitcnt vmcnt(1)
    v_and_b32 v120, 0x7fc, v88
    v_bfe_i32 v122, v88, 2, 1
    v_lshl_add_u32 v122, v122, 4, 8
    s_mov_b64 exec, s[64:65]
    ds_add_rtn_u32 v112, v120, v122 offset:0
    s_mov_b64 exec, -1
    v_and_b32 v121, 0x7fc, v89
    v_bfe_i32 v123, v89, 2, 1
    v_lshl_add_u32 v123, v123, 4, 8
    s_mov_b64 exec, s[66:67]
    ds_add_rtn_u32 v113, v121, v123 offset:0
    s_mov_b64 exec, -1
    s_waitcnt vmcnt(0)
    v_and_b32 v120, 0x7fc, v92
    v_bfe_i32 v122, v92, 2, 1
    v_lshl_add_u32 v122, v122, 4, 8
    s_mov_b64 exec, s[68:69]
    ds_add_rtn_u32 v114, v120, v122 offset:0
    s_mov_b64 exec, -1
    v_and_b32 v121, 0x7fc, v93
    v_bfe_i32 v123, v93, 2, 1
    v_lshl_add_u32 v123, v123, 4, 8
    s_mov_b64 exec, s[70:71]
    ds_add_rtn_u32 v115, v121, v123 offset:0
    s_mov_b64 exec, -1
    buffer_load_dwordx2 v[54:55], v52, s[12:15], s32 offen offset:0
    buffer_load_dwordx2 v[56:57], v52, s[12:15], s32 offen offset:256
    buffer_load_dwordx2 v[58:59], v52, s[12:15], s32 offen offset:512
    buffer_load_dwordx2 v[60:61], v52, s[12:15], s32 offen offset:768
    buffer_load_dwordx2 v[62:63], v52, s[12:15], s32 offen offset:1024
    s_waitcnt lgkmcnt(0)
    v_med3_i32 v112, v112, v126, s35
    v_lshlrev_b32 v91, 16, v90
    s_mov_b64 exec, s[64:65]
    ds_write2_b32 v112, v88, v91 offset0:0 offset1:1
    s_mov_b64 exec, -1
    v_med3_i32 v113, v113, v126, s35
    v_and_b32 v90, s34, v90
    s_mov_b64 exec, s[66:67]
    ds_write2_b32 v113, v89, v90 offset0:0 offset1:1
    s_mov_b64 exec, -1
    v_med3_i32 v114, v114, v126, s35
    v_lshlrev_b32 v95, 16, v94
    s_mov_b64 exec, s[68:69]
    ds_write2_b32 v114, v92, v95 offset0:0 offset1:1
    s_mov_b64 exec, -1
    v_med3_i32 v115, v115, v126, s35
    v_and_b32 v94, s34, v94
    s_mov_b64 exec, s[70:71]
    ds_write2_b32 v115, v93, v94 offset0:0 offset1:1
    s_mov_b64 exec, -1
    s_cmp_eq_u32 s36, 0
    s_cbranch_scc1 K_nox2
    v_and_b32 v120, 0x7fc, v96
    v_bfe_i32 v122, v96, 2, 1
    v_lshl_add_u32 v122, v122, 4, 8
    s_mov_b64 exec, s[72:73]
    ds_add_rtn_u32 v112, v120, v122 offset:0
    s_mov_b64 exec, -1
    v_and_b32 v121, 0x7fc, v97
    v_bfe_i32 v123, v97, 2, 1
    v_lshl_add_u32 v123, v123, 4, 8
    s_mov_b64 exec, s[74:75]
    ds_add_rtn_u32 v113, v121, v123 offset:0
    s_mov_b64 exec, -1
    v_and_b32 v120, 0x7fc, v100
    v_bfe_i32 v122, v100, 2, 1
    v_lshl_add_u32 v122, v122, 4, 8
    s_mov_b64 exec, s[76:77]
    ds_add_rtn_u32 v114, v120, v122 offset:0
    s_mov_b64 exec, -1
    v_and_b32 v121, 0x7fc, v101
    v_bfe_i32 v123, v101, 2, 1
    v_lshl_add_u32 v123, v123, 4, 8
    s_mov_b64 exec, s[78:79]
    ds_add_rtn_u32 v115, v121, v123 offset:0
    s_mov_b64 exec, -1
    s_waitcnt lgkmcnt(0)
    v_med3_i32 v112, v112, v126, s35
    v_lshlrev_b32 v99, 16, v98
    s_mov_b64 exec, s[72:73]
    ds_write2_b32 v112, v96, v99 offset0:0 offset1:1
    s_mov_b64 exec, -1
    v_med3_i32 v113, v113, v126, s35
    v_and_b32 v98, s34, v98
    s_mov_b64 exec, s[74:75]
    ds_write2_b32 v113, v97, v98 offset0:0 offset1:1
    s_mov_b64 exec, -1
    v_med3_i32 v114, v114, v126, s35
    v_lshlrev_b32 v103, 16, v102
    s_mov_b64 exec, s[76:77]
    ds_write2_b32 v114, v100, v103 offset0:0 offset1:1
    s_mov_b64 exec, -1
    v_med3_i32 v115, v115, v126, s35
    v_and_b32 v102, s34, v102
    s_mov_b64 exec, s[78:79]
    ds_write2_b32 v115, v101, v102 offset0:0 offset1:1
    s_mov_b64 exec, -1
K_nox2:
    s_waitcnt lgkmcnt(0)
    s_barrier
K_params:
    s_mul_i32 s80, s3, 80
    v_lshlrev_b32 v113, 4, v1
    v_add_u32 v112, s80, v113
    ds_read_b128 v[96:99], v112 offset:0
    ds_read_b128 v[118:121], v112 offset:1280
    v_mov_b32 v53, v3
    s_waitcnt lgkmcnt(0)
    v_sub_u32 v122, v97, v96
    v_sub_u32 v123, v99, v98
    v_add_u32 v126, 8, v121
    v_add_u32 v122, 8, v122
    v_add_u32 v123, 8, v123
    v_readlane_b32 s40, v118, 0
    v_readlane_b32 s45, v96, 0
    v_readlane_b32 s55, v98, 0
    v_readlane_b32 s65, v126, 0
    v_readlane_b32 s50, v122, 0
    v_readlane_b32 s60, v123, 0
    s_nop 0
    v_add_u32 v114, s40, v53
    v_cmpx_le_u32 vcc, s45, v114
    v_add_u32 v114, s50, v114
    v_cmpx_le_u32 vcc, s55, v114
    v_add_u32 v114, s60, v114
    v_cmpx_le_u32 vcc, s65, v114
    v_mov_b32 v114, 2592
    s_mov_b64 exec, -1
    ds_read_b64 v[100:101], v114
    s_nop 1
    v_readlane_b32 s41, v118, 1
    v_readlane_b32 s46, v96, 1
    v_readlane_b32 s56, v98, 1
    v_readlane_b32 s66, v126, 1
    v_readlane_b32 s51, v122, 1
    v_readlane_b32 s61, v123, 1
    s_nop 0
    v_add_u32 v115, s41, v53
    v_cmpx_le_u32 vcc, s46, v115
    v_add_u32 v115, s51, v115
    v_cmpx_le_u32 vcc, s56, v115
    v_add_u32 v115, s61, v115
    v_cmpx_le_u32 vcc, s66, v115
    v_mov_b32 v115, 2592
    s_mov_b64 exec, -1
    ds_read_b64 v[102:103], v115
    s_waitcnt lgkmcnt(1)
    v_lshrrev_b32 v116, 9, v100
    v_and_or_b32 v116, v116, s33, v2
    buffer_load_dwordx4 v[64:67], v116, s[12:15], 0 offen
    v_mul_f32 v117, v101, v6
    v_bfe_u32 v84, v100, 11, 3
    v_fract_f32 v117, v117
    v_lshl_add_u32 v84, v84, 7, v4
    v_cos_f32 v117, v117
    s_nop 0
    v_cvt_pk_bf16_f32 v89, v117, v117
    s_nop 1
    v_readlane_b32 s42, v118, 2
    v_readlane_b32 s47, v96, 2
    v_readlane_b32 s57, v98, 2
    v_readlane_b32 s67, v126, 2
    v_readlane_b32 s52, v122, 2
    v_readlane_b32 s62, v123, 2
    s_nop 0
    v_add_u32 v114, s42, v53
    v_cmpx_le_u32 vcc, s47, v114
    v_add_u32 v114, s52, v114
    v_cmpx_le_u32 vcc, s57, v114
    v_add_u32 v114, s62, v114
    v_cmpx_le_u32 vcc, s67, v114
    v_mov_b32 v114, 2592
    s_mov_b64 exec, -1
    ds_read_b64 v[104:105], v114
    s_waitcnt lgkmcnt(1)
    v_lshrrev_b32 v116, 9, v102
    v_and_or_b32 v116, v116, s33, v2
    buffer_load_dwordx4 v[68:71], v116, s[12:15], 0 offen
    v_mul_f32 v117, v103, v6
    v_bfe_u32 v85, v102, 11, 3
    v_fract_f32 v117, v117
    v_lshl_add_u32 v85, v85, 7, v4
    v_cos_f32 v117, v117
    s_nop 0
    v_cvt_pk_bf16_f32 v90, v117, v117
    s_nop 1
    v_readlane_b32 s43, v118, 3
    v_readlane_b32 s48, v96, 3
    v_readlane_b32 s58, v98, 3
    v_readlane_b32 s68, v126, 3
    v_readlane_b32 s53, v122, 3
    v_readlane_b32 s63, v123, 3
    s_nop 0
    v_add_u32 v115, s43, v53
    v_cmpx_le_u32 vcc, s48, v115
    v_add_u32 v115, s53, v115
    v_cmpx_le_u32 vcc, s58, v115
    v_add_u32 v115, s63, v115
    v_cmpx_le_u32 vcc, s68, v115
    v_mov_b32 v115, 2592
    s_mov_b64 exec, -1
    ds_read_b64 v[106:107], v115
    s_waitcnt lgkmcnt(1)
    v_lshrrev_b32 v116, 9, v104
    v_and_or_b32 v116, v116, s33, v2
    buffer_load_dwordx4 v[72:75], v116, s[12:15], 0 offen
    v_mul_f32 v117, v105, v6
    v_bfe_u32 v86, v104, 11, 3
    v_fract_f32 v117, v117
    v_lshl_add_u32 v86, v86, 7, v4
    v_cos_f32 v117, v117
    s_nop 0
    v_cvt_pk_bf16_f32 v91, v117, v117
    s_nop 1
    v_readlane_b32 s44, v118, 4
    v_readlane_b32 s49, v96, 4
    v_readlane_b32 s59, v98, 4
    v_readlane_b32 s69, v126, 4
    v_readlane_b32 s54, v122, 4
    v_readlane_b32 s64, v123, 4
    s_nop 0
    v_add_u32 v114, s44, v53
    v_cmpx_le_u32 vcc, s49, v114
    v_add_u32 v114, s54, v114
    v_cmpx_le_u32 vcc, s59, v114
    v_add_u32 v114, s64, v114
    v_cmpx_le_u32 vcc, s69, v114
    v_mov_b32 v114, 2592
    s_mov_b64 exec, -1
    ds_read_b64 v[108:109], v114
    s_waitcnt lgkmcnt(1)
    v_lshrrev_b32 v116, 9, v106
    v_and_or_b32 v116, v116, s33, v2
    buffer_load_dwordx4 v[76:79], v116, s[12:15], 0 offen
    v_mul_f32 v117, v107, v6
    v_bfe_u32 v87, v106, 11, 3
    v_fract_f32 v117, v117
    v_lshl_add_u32 v87, v87, 7, v4
    v_cos_f32 v117, v117
    s_nop 0
    v_cvt_pk_bf16_f32 v92, v117, v117
    s_waitcnt lgkmcnt(0)
    v_lshrrev_b32 v116, 9, v108
    v_and_or_b32 v116, v116, s33, v2
    buffer_load_dwordx4 v[80:83], v116, s[12:15], 0 offen
    v_mul_f32 v117, v109, v6
    v_bfe_u32 v88, v108, 11, 3
    v_fract_f32 v117, v117
    v_lshl_add_u32 v88, v88, 7, v4
    v_cos_f32 v117, v117
    s_nop 0
    v_cvt_pk_bf16_f32 v93, v117, v117
    v_lshlrev_b32 v113, 4, v1
    v_add_u32 v53, 256, v53
    ds_read_b32 v115, v7 offset:2564
    ds_read_b128 v[104:107], v113 offset:0
    v_and_b32 v114, 0xf0, v113
    ds_read_b128 v[108:111], v114 offset:1024
    v_sub_u32 v100, v96, v118
    v_sub_u32 v101, v119, v97
    v_add_u32 v100, v100, v101
    v_sub_u32 v101, v98, v120
    v_add_u32 v100, v100, v101
    v_sub_u32 v101, v121, v99
    v_add_u32 v100, v100, v101
    v_add_u32 v100, 255, v100
    v_lshrrev_b32 v100, 8, v100
    v_min_u32 v100, 640, v100
    s_nop 0
    v_readlane_b32 s70, v100, 0
    v_readlane_b32 s71, v100, 1
    v_readlane_b32 s72, v100, 2
    v_readlane_b32 s73, v100, 3
    v_readlane_b32 s74, v100, 4
    s_waitcnt lgkmcnt(0)
    v_readfirstlane_b32 s29, v115
    s_max_u32 s31, s70, 4
    s_max_u32 s31, s31, s71
    s_max_u32 s31, s31, s72
    s_max_u32 s31, s31, s73
    s_max_u32 s31, s31, s74
    s_sub_u32 s31, s31, 1
    s_mov_b32 s30, 0
    s_cmp_lg_u32 s27, 0
    s_cbranch_scc1 K_nochk
    v_add_u32 v105, 8, v105
    v_add_u32 v107, 8, v107
    v_add_u32 v109, 8, v109
    v_add_u32 v111, 8, v111
    v_cmp_gt_i32 vcc, v104, v105
    v_cmp_gt_i32_e64 s[82:83], v106, v107
    v_cmp_gt_i32_e64 s[84:85], v108, v109
    v_cmp_gt_i32_e64 s[86:87], v110, v111
    s_or_b64 vcc, vcc, s[82:83]
    s_or_b64 vcc, vcc, s[84:85]
    s_or_b64 vcc, vcc, s[86:87]
    s_cmp_gt_u32 s29, 80
    s_cselect_b32 s82, 1, 0
    s_cmp_lg_u64 vcc, 0
    s_cselect_b32 s83, 1, 0
    s_or_b32 s82, s82, s83
    s_cmp_eq_u32 s82, 0
    s_cbranch_scc1 K_nochk
    s_mov_b32 s27, 1
    s_mov_b32 s36, 0
    s_mov_b32 s28, 0
    s_waitcnt vmcnt(0)
    s_barrier
K_slow_next:
    v_min_u32 v112, 319, v0
    v_lshlrev_b32 v112, 2, v112
    ds_write_b32 v112, v7 offset:0
    s_waitcnt lgkmcnt(0)
    s_barrier
    v_lshrrev_b32 v113, 5, v1
    v_and_b32 v115, 31, v1
    v_lshlrev_b32 v118, 2, v113
    v_add_u32 v115, s28, v115
    v_mul_u32_u24 v114, 12, v115
    v_lshlrev_b32 v115, 1, v115
    v_lshl_add_u32 v114, v113, 19, v114
    v_add_u32 v116, 1, v115
    s_branch K_round
    s_nop 0
    s_nop 0
    s_nop 0
    s_nop 0
    s_nop 0
K_nochk:
    v_add_u32 v114, s40, v53
    v_cmpx_le_u32 vcc, s45, v114
    v_add_u32 v114, s50, v114
    v_cmpx_le_u32 vcc, s55, v114
    v_add_u32 v114, s60, v114
    v_cmpx_le_u32 vcc, s65, v114
    v_mov_b32 v114, 2592
    s_mov_b64 exec, -1
    ds_read_b64 v[112:113], v114
    s_cmp_lg_u32 s28, 0
    s_cbranch_scc1 K_norbf
    v_and_b32 v111, 1, v1
    v_lshlrev_b32 v111, 4, v111
    v_sub_f32 v96, v8, v9
    v_sub_f32 v97, v8, v11
    v_sub_f32 v99, v10, v9
    v_sub_f32 v100, v10, v11
    v_sub_f32 v102, v48, v9
    v_sub_f32 v103, v48, v11
    v_sub_f32 v105, v50, v9
    v_sub_f32 v106, v50, v11
    v_sub_f32 v108, v124, v9
    v_sub_f32 v109, v124, v11
    v_cvt_pk_bf16_f32 v98, v96, v97
    v_cvt_pk_bf16_f32 v101, v99, v100
    v_cvt_pk_bf16_f32 v104, v102, v103
    v_cvt_pk_bf16_f32 v107, v105, v106
    v_cvt_pk_bf16_f32 v110, v108, v109
    v_lshlrev_b32 v96, 16, v98
    v_and_b32 v97, s34, v98
    v_lshlrev_b32 v99, 16, v101
    v_and_b32 v100, s34, v101
    v_lshlrev_b32 v102, 16, v104
    v_and_b32 v103, s34, v104
    v_lshlrev_b32 v105, 16, v107
    v_and_b32 v106, s34, v107
    v_lshlrev_b32 v108, 16, v110
    v_and_b32 v109, s34, v110
    v_mul_f32 v96, v96, v96
    v_mul_f32 v97, v97, v97
    v_mul_f32 v99, v99, v99
    v_mul_f32 v100, v100, v100
    v_mul_f32 v102, v102, v102
    v_mul_f32 v103, v103, v103
    v_mul_f32 v105, v105, v105
    v_mul_f32 v106, v106, v106
    v_mul_f32 v108, v108, v108
    v_mul_f32 v109, v109, v109
    v_cvt_pk_bf16_f32 v98, v96, v97
    v_cvt_pk_bf16_f32 v101, v99, v100
    v_cvt_pk_bf16_f32 v104, v102, v103
    v_cvt_pk_bf16_f32 v107, v105, v106
    v_cvt_pk_bf16_f32 v110, v108, v109
    v_lshlrev_b32 v96, 16, v98
    v_and_b32 v97, s34, v98
    v_lshlrev_b32 v99, 16, v101
    v_and_b32 v100, s34, v101
    v_lshlrev_b32 v102, 16, v104
    v_and_b32 v103, s34, v104
    v_lshlrev_b32 v105, 16, v107
    v_and_b32 v106, s34, v107
    v_lshlrev_b32 v108, 16, v110
    v_and_b32 v109, s34, v110
    v_mul_f32 v96, 0xc1200000, v96
    v_mul_f32 v97, 0xc1200000, v97
    v_mul_f32 v99, 0xc1200000, v99
    v_mul_f32 v100, 0xc1200000, v100
    v_mul_f32 v102, 0xc1200000, v102
    v_mul_f32 v103, 0xc1200000, v103
    v_mul_f32 v105, 0xc1200000, v105
    v_mul_f32 v106, 0xc1200000, v106
    v_mul_f32 v108, 0xc1200000, v108
    v_mul_f32 v109, 0xc1200000, v109
    v_cvt_pk_bf16_f32 v98, v96, v97
    v_cvt_pk_bf16_f32 v101, v99, v100
    v_cvt_pk_bf16_f32 v104, v102, v103
    v_cvt_pk_bf16_f32 v107, v105, v106
    v_cvt_pk_bf16_f32 v110, v108, v109
    v_lshlrev_b32 v96, 16, v98
    v_and_b32 v97, s34, v98
    v_lshlrev_b32 v99, 16, v101
    v_and_b32 v100, s34, v101
    v_lshlrev_b32 v102, 16, v104
    v_and_b32 v103, s34, v104
    v_lshlrev_b32 v105, 16, v107
    v_and_b32 v106, s34, v107
    v_lshlrev_b32 v108, 16, v110
    v_and_b32 v109, s34, v110
    v_mul_f32 v96, 0x3fb8aa3b, v96
    v_mul_f32 v97, 0x3fb8aa3b, v97
    v_mul_f32 v99, 0x3fb8aa3b, v99
    v_mul_f32 v100, 0x3fb8aa3b, v100
    v_mul_f32 v102, 0x3fb8aa3b, v102
    v_mul_f32 v103, 0x3fb8aa3b, v103
    v_mul_f32 v105, 0x3fb8aa3b, v105
    v_mul_f32 v106, 0x3fb8aa3b, v106
    v_mul_f32 v108, 0x3fb8aa3b, v108
    v_mul_f32 v109, 0x3fb8aa3b, v109
    v_exp_f32 v96, v96
    v_exp_f32 v97, v97
    v_exp_f32 v99, v99
    v_exp_f32 v100, v100
    v_exp_f32 v102, v102
    v_exp_f32 v103, v103
    v_exp_f32 v105, v105
    v_exp_f32 v106, v106
    v_exp_f32 v108, v108
    v_exp_f32 v109, v109
    s_nop 0
    v_cvt_pk_bf16_f32 v98, v96, v97
    v_cvt_pk_bf16_f32 v101, v99, v100
    v_cvt_pk_bf16_f32 v104, v102, v103
    v_cvt_pk_bf16_f32 v107, v105, v106
    v_cvt_pk_bf16_f32 v110, v108, v109
    v_and_b32 v96, 0xffff, v98
    v_lshrrev_b32 v97, 16, v98
    v_and_b32 v99, 0xffff, v101
    v_lshrrev_b32 v100, 16, v101
    v_and_b32 v102, 0xffff, v104
    v_lshrrev_b32 v103, 16, v104
    v_and_b32 v105, 0xffff, v107
    v_lshrrev_b32 v106, 16, v107
    v_and_b32 v108, 0xffff, v110
    v_lshrrev_b32 v109, 16, v110
    v_lshlrev_b32 v8, v111, v96
    v_lshlrev_b32 v9, v111, v97
    v_lshlrev_b32 v10, v111, v99
    v_lshlrev_b32 v11, v111, v100
    v_lshlrev_b32 v48, v111, v102
    v_lshlrev_b32 v49, v111, v103
    v_lshlrev_b32 v50, v111, v105
    v_lshlrev_b32 v51, v111, v106
    v_lshlrev_b32 v124, v111, v108
    v_lshlrev_b32 v125, v111, v109
K_norbf:
    s_movk_i32 s98, 2592
K_step:
K_blk_0:
    s_cmp_lt_u32 s30, s70
    s_cbranch_scc0 K_skip_0
    ds_write_b16 v84, v89
    ds_read_b128 v[96:99], v5
    ds_write_b16 v84, v7
    s_waitcnt vmcnt(4) lgkmcnt(3)
    v_mfma_f32_16x16x32_bf16 v[100:103], v[64:67], v[20:23], 0
    v_mfma_f32_16x16x32_bf16 v[104:107], v[64:67], v[24:27], 0
    v_lshrrev_b32 v116, 9, v112
    v_and_or_b32 v116, v116, s33, v2
    buffer_load_dwordx4 v[64:67], v116, s[12:15], 0 offen
    v_mul_f32 v117, v113, v6
    v_bfe_u32 v84, v112, 11, 3
    v_fract_f32 v117, v117
    v_lshl_add_u32 v84, v84, 7, v4
    v_cos_f32 v117, v117
    v_add_u32 v114, s41, v53
    v_cmpx_le_u32 vcc, s46, v114
    v_add_u32 v114, s51, v114
    v_cmpx_le_u32 vcc, s56, v114
    v_add_u32 v114, s61, v114
    v_cmpx_le_u32 vcc, s66, v114
    v_mov_b32 v114, s98
    s_mov_b64 exec, -1
    ds_read_b64 v[112:113], v114
    v_cvt_pk_bf16_f32 v108, v100, v101
    v_cvt_pk_bf16_f32 v109, v102, v103
    v_cvt_pk_bf16_f32 v110, v104, v105
    v_cvt_pk_bf16_f32 v111, v106, v107
    v_cvt_pk_bf16_f32 v89, v117, v117
    s_waitcnt lgkmcnt(2)
    v_mfma_f32_16x16x32_bf16 v[28:31], v[108:111], v[96:99], v[28:31]
K_blk_1:
    s_cmp_lt_u32 s30, s71
    s_cbranch_scc0 K_skip_1
    ds_write_b16 v85, v90
    ds_read_b128 v[96:99], v5
    ds_write_b16 v85, v7
    s_waitcnt vmcnt(4) lgkmcnt(3)
    v_mfma_f32_16x16x32_bf16 v[100:103], v[68:71], v[20:23], 0
    v_mfma_f32_16x16x32_bf16 v[104:107], v[68:71], v[24:27], 0
    v_lshrrev_b32 v116, 9, v112
    v_and_or_b32 v116, v116, s33, v2
    buffer_load_dwordx4 v[68:71], v116, s[12:15], 0 offen
    v_mul_f32 v117, v113, v6
    v_bfe_u32 v85, v112, 11, 3
    v_fract_f32 v117, v117
    v_lshl_add_u32 v85, v85, 7, v4
    v_cos_f32 v117, v117
    v_add_u32 v114, s42, v53
    v_cmpx_le_u32 vcc, s47, v114
    v_add_u32 v114, s52, v114
    v_cmpx_le_u32 vcc, s57, v114
    v_add_u32 v114, s62, v114
    v_cmpx_le_u32 vcc, s67, v114
    v_mov_b32 v114, s98
    s_mov_b64 exec, -1
    ds_read_b64 v[112:113], v114
    v_cvt_pk_bf16_f32 v108, v100, v101
    v_cvt_pk_bf16_f32 v109, v102, v103
    v_cvt_pk_bf16_f32 v110, v104, v105
    v_cvt_pk_bf16_f32 v111, v106, v107
    v_cvt_pk_bf16_f32 v90, v117, v117
    s_waitcnt lgkmcnt(2)
    v_mfma_f32_16x16x32_bf16 v[32:35], v[108:111], v[96:99], v[32:35]
K_blk_2:
    s_cmp_lt_u32 s30, s72
    s_cbranch_scc0 K_skip_2
    ds_write_b16 v86, v91
    ds_read_b128 v[96:99], v5
    ds_write_b16 v86, v7
    s_waitcnt vmcnt(4) lgkmcnt(3)
    v_mfma_f32_16x16x32_bf16 v[100:103], v[72:75], v[20:23], 0
    v_mfma_f32_16x16x32_bf16 v[104:107], v[72:75], v[24:27], 0
    v_lshrrev_b32 v116, 9, v112
    v_and_or_b32 v116, v116, s33, v2
    buffer_load_dwordx4 v[72:75], v116, s[12:15], 0 offen
    v_mul_f32 v117, v113, v6
    v_bfe_u32 v86, v112, 11, 3
    v_fract_f32 v117, v117
    v_lshl_add_u32 v86, v86, 7, v4
    v_cos_f32 v117, v117
    v_add_u32 v114, s43, v53
    v_cmpx_le_u32 vcc, s48, v114
    v_add_u32 v114, s53, v114
    v_cmpx_le_u32 vcc, s58, v114
    v_add_u32 v114, s63, v114
    v_cmpx_le_u32 vcc, s68, v114
    v_mov_b32 v114, s98
    s_mov_b64 exec, -1
    ds_read_b64 v[112:113], v114
    v_cvt_pk_bf16_f32 v108, v100, v101
    v_cvt_pk_bf16_f32 v109, v102, v103
    v_cvt_pk_bf16_f32 v110, v104, v105
    v_cvt_pk_bf16_f32 v111, v106, v107
    v_cvt_pk_bf16_f32 v91, v117, v117
    s_waitcnt lgkmcnt(2)
    v_mfma_f32_16x16x32_bf16 v[36:39], v[108:111], v[96:99], v[36:39]
K_blk_3:
    s_cmp_lt_u32 s30, s73
    s_cbranch_scc0 K_skip_3
    ds_write_b16 v87, v92
    ds_read_b128 v[96:99], v5
    ds_write_b16 v87, v7
    s_waitcnt vmcnt(4) lgkmcnt(3)
    v_mfma_f32_16x16x32_bf16 v[100:103], v[76:79], v[20:23], 0
    v_mfma_f32_16x16x32_bf16 v[104:107], v[76:79], v[24:27], 0
    v_lshrrev_b32 v116, 9, v112
    v_and_or_b32 v116, v116, s33, v2
    buffer_load_dwordx4 v[76:79], v116, s[12:15], 0 offen
    v_mul_f32 v117, v113, v6
    v_bfe_u32 v87, v112, 11, 3
    v_fract_f32 v117, v117
    v_lshl_add_u32 v87, v87, 7, v4
    v_cos_f32 v117, v117
    v_add_u32 v114, s44, v53
    v_cmpx_le_u32 vcc, s49, v114
    v_add_u32 v114, s54, v114
    v_cmpx_le_u32 vcc, s59, v114
    v_add_u32 v114, s64, v114
    v_cmpx_le_u32 vcc, s69, v114
    v_mov_b32 v114, s98
    s_mov_b64 exec, -1
    ds_read_b64 v[112:113], v114
    v_cvt_pk_bf16_f32 v108, v100, v101
    v_cvt_pk_bf16_f32 v109, v102, v103
    v_cvt_pk_bf16_f32 v110, v104, v105
    v_cvt_pk_bf16_f32 v111, v106, v107
    v_cvt_pk_bf16_f32 v92, v117, v117
    s_waitcnt lgkmcnt(2)
    v_mfma_f32_16x16x32_bf16 v[40:43], v[108:111], v[96:99], v[40:43]
K_blk_4:
    s_cmp_lt_u32 s30, s74
    s_cbranch_scc0 K_skip_4
    ds_write_b16 v88, v93
    ds_read_b128 v[96:99], v5
    ds_write_b16 v88, v7
    s_waitcnt vmcnt(4) lgkmcnt(3)
    v_mfma_f32_16x16x32_bf16 v[100:103], v[80:83], v[20:23], 0
    v_mfma_f32_16x16x32_bf16 v[104:107], v[80:83], v[24:27], 0
    v_lshrrev_b32 v116, 9, v112
    v_and_or_b32 v116, v116, s33, v2
    buffer_load_dwordx4 v[80:83], v116, s[12:15], 0 offen
    v_mul_f32 v117, v113, v6
    v_bfe_u32 v88, v112, 11, 3
    v_fract_f32 v117, v117
    v_lshl_add_u32 v88, v88, 7, v4
    v_cos_f32 v117, v117
    v_add_u32 v53, 256, v53
    v_add_u32 v114, s40, v53
    v_cmpx_le_u32 vcc, s45, v114
    v_add_u32 v114, s50, v114
    v_cmpx_le_u32 vcc, s55, v114
    v_add_u32 v114, s60, v114
    v_cmpx_le_u32 vcc, s65, v114
    v_mov_b32 v114, s98
    s_mov_b64 exec, -1
    ds_read_b64 v[112:113], v114
    v_cvt_pk_bf16_f32 v108, v100, v101
    v_cvt_pk_bf16_f32 v109, v102, v103
    v_cvt_pk_bf16_f32 v110, v104, v105
    v_cvt_pk_bf16_f32 v111, v106, v107
    v_cvt_pk_bf16_f32 v93, v117, v117
    s_waitcnt lgkmcnt(2)
    v_mfma_f32_16x16x32_bf16 v[44:47], v[108:111], v[96:99], v[44:47]
K_stepend:
    s_add_u32 s30, s30, 1
    s_cmp_gt_u32 s30, 2
    s_cbranch_scc1 K_nobar
    s_barrier
K_nobar:
    s_cmp_lt_u32 s30, s31
    s_cbranch_scc1 K_step
    s_cmp_lt_u32 s30, s70
    s_cbranch_scc0 K_last_0
    ds_write_b16 v84, v89
    ds_read_b128 v[96:99], v5
    ds_write_b16 v84, v7
    s_waitcnt vmcnt(4)
    v_mfma_f32_16x16x32_bf16 v[100:103], v[64:67], v[20:23], 0
    v_mfma_f32_16x16x32_bf16 v[104:107], v[64:67], v[24:27], 0
    s_nop 7
    v_cvt_pk_bf16_f32 v108, v100, v101
    v_cvt_pk_bf16_f32 v109, v102, v103
    v_cvt_pk_bf16_f32 v110, v104, v105
    v_cvt_pk_bf16_f32 v111, v106, v107
    s_nop 0
    s_waitcnt lgkmcnt(1)
    v_mfma_f32_16x16x32_bf16 v[28:31], v[108:111], v[96:99], v[28:31]
K_last_0:
    s_cmp_lt_u32 s30, s71
    s_cbranch_scc0 K_last_1
    ds_write_b16 v85, v90
    ds_read_b128 v[96:99], v5
    ds_write_b16 v85, v7
    s_waitcnt vmcnt(3)
    v_mfma_f32_16x16x32_bf16 v[100:103], v[68:71], v[20:23], 0
    v_mfma_f32_16x16x32_bf16 v[104:107], v[68:71], v[24:27], 0
    s_nop 7
    v_cvt_pk_bf16_f32 v108, v100, v101
    v_cvt_pk_bf16_f32 v109, v102, v103
    v_cvt_pk_bf16_f32 v110, v104, v105
    v_cvt_pk_bf16_f32 v111, v106, v107
    s_nop 0
    s_waitcnt lgkmcnt(1)
    v_mfma_f32_16x16x32_bf16 v[32:35], v[108:111], v[96:99], v[32:35]
K_last_1:
    s_cmp_lt_u32 s30, s72
    s_cbranch_scc0 K_last_2
    ds_write_b16 v86, v91
    ds_read_b128 v[96:99], v5
    ds_write_b16 v86, v7
    s_waitcnt vmcnt(2)
    v_mfma_f32_16x16x32_bf16 v[100:103], v[72:75], v[20:23], 0
    v_mfma_f32_16x16x32_bf16 v[104:107], v[72:75], v[24:27], 0
    s_nop 7
    v_cvt_pk_bf16_f32 v108, v100, v101
    v_cvt_pk_bf16_f32 v109, v102, v103
    v_cvt_pk_bf16_f32 v110, v104, v105
    v_cvt_pk_bf16_f32 v111, v106, v107
    s_nop 0
    s_waitcnt lgkmcnt(1)
    v_mfma_f32_16x16x32_bf16 v[36:39], v[108:111], v[96:99], v[36:39]
K_last_2:
    s_cmp_lt_u32 s30, s73
    s_cbranch_scc0 K_last_3
    ds_write_b16 v87, v92
    ds_read_b128 v[96:99], v5
    ds_write_b16 v87, v7
    s_waitcnt vmcnt(1)
    v_mfma_f32_16x16x32_bf16 v[100:103], v[76:79], v[20:23], 0
    v_mfma_f32_16x16x32_bf16 v[104:107], v[76:79], v[24:27], 0
    s_nop 7
    v_cvt_pk_bf16_f32 v108, v100, v101
    v_cvt_pk_bf16_f32 v109, v102, v103
    v_cvt_pk_bf16_f32 v110, v104, v105
    v_cvt_pk_bf16_f32 v111, v106, v107
    s_nop 0
    s_waitcnt lgkmcnt(1)
    v_mfma_f32_16x16x32_bf16 v[40:43], v[108:111], v[96:99], v[40:43]
K_last_3:
    s_cmp_lt_u32 s30, s74
    s_cbranch_scc0 K_last_4
    ds_write_b16 v88, v93
    ds_read_b128 v[96:99], v5
    ds_write_b16 v88, v7
    s_waitcnt vmcnt(0)
    v_mfma_f32_16x16x32_bf16 v[100:103], v[80:83], v[20:23], 0
    v_mfma_f32_16x16x32_bf16 v[104:107], v[80:83], v[24:27], 0
    s_nop 7
    v_cvt_pk_bf16_f32 v108, v100, v101
    v_cvt_pk_bf16_f32 v109, v102, v103
    v_cvt_pk_bf16_f32 v110, v104, v105
    v_cvt_pk_bf16_f32 v111, v106, v107
    s_nop 0
    s_waitcnt lgkmcnt(1)
    v_mfma_f32_16x16x32_bf16 v[44:47], v[108:111], v[96:99], v[44:47]
K_last_4:
    s_waitcnt vmcnt(0) lgkmcnt(0)
    s_cmp_eq_u32 s27, 0
    s_cbranch_scc1 K_fin
    s_add_u32 s28, s28, 32
    s_lshl_b32 s80, s28, 1
    s_cmp_ge_u32 s80, s29
    s_cbranch_scc1 K_fin
    s_barrier
    s_branch K_slow_next
K_fin:
    s_nop 7
    v_mfma_f32_16x16x16_bf16 v[64:67], v[14:15], v[8:9], 0
    v_mfma_f32_16x16x16_bf16 v[68:71], v[14:15], v[10:11], 0
    v_mfma_f32_16x16x16_bf16 v[72:75], v[14:15], v[48:49], 0
    v_mfma_f32_16x16x16_bf16 v[76:79], v[14:15], v[50:51], 0
    v_mfma_f32_16x16x16_bf16 v[80:83], v[14:15], v[124:125], 0
    v_mfma_f32_16x16x16_bf16 v[84:87], v[18:19], v[8:9], 0
    v_mfma_f32_16x16x16_bf16 v[88:91], v[18:19], v[10:11], 0
    v_mfma_f32_16x16x16_bf16 v[92:95], v[18:19], v[48:49], 0
    v_mfma_f32_16x16x16_bf16 v[96:99], v[18:19], v[50:51], 0
    v_mfma_f32_16x16x16_bf16 v[100:103], v[18:19], v[124:125], 0
    v_pk_mul_f32 v[64:65], v[64:65], v[28:29]
    v_pk_mul_f32 v[66:67], v[66:67], v[30:31]
    v_pk_mul_f32 v[68:69], v[68:69], v[32:33]
    v_pk_mul_f32 v[70:71], v[70:71], v[34:35]
    v_pk_mul_f32 v[72:73], v[72:73], v[36:37]
    v_pk_mul_f32 v[74:75], v[74:75], v[38:39]
    v_pk_mul_f32 v[76:77], v[76:77], v[40:41]
    v_pk_mul_f32 v[78:79], v[78:79], v[42:43]
    v_pk_mul_f32 v[80:81], v[80:81], v[44:45]
    v_pk_mul_f32 v[82:83], v[82:83], v[46:47]
    s_nop 1
    v_add_f32_dpp v28, v64, v64 quad_perm:[1,0,3,2] row_mask:0xf bank_mask:0xf
    v_add_f32_dpp v29, v65, v65 quad_perm:[1,0,3,2] row_mask:0xf bank_mask:0xf
    v_add_f32_dpp v30, v66, v66 quad_perm:[1,0,3,2] row_mask:0xf bank_mask:0xf
    v_add_f32_dpp v31, v67, v67 quad_perm:[1,0,3,2] row_mask:0xf bank_mask:0xf
    v_add_f32_dpp v32, v68, v68 quad_perm:[1,0,3,2] row_mask:0xf bank_mask:0xf
    v_add_f32_dpp v33, v69, v69 quad_perm:[1,0,3,2] row_mask:0xf bank_mask:0xf
    v_add_f32_dpp v34, v70, v70 quad_perm:[1,0,3,2] row_mask:0xf bank_mask:0xf
    v_add_f32_dpp v35, v71, v71 quad_perm:[1,0,3,2] row_mask:0xf bank_mask:0xf
    v_add_f32_dpp v36, v72, v72 quad_perm:[1,0,3,2] row_mask:0xf bank_mask:0xf
    v_add_f32_dpp v37, v73, v73 quad_perm:[1,0,3,2] row_mask:0xf bank_mask:0xf
    v_add_f32_dpp v38, v74, v74 quad_perm:[1,0,3,2] row_mask:0xf bank_mask:0xf
    v_add_f32_dpp v39, v75, v75 quad_perm:[1,0,3,2] row_mask:0xf bank_mask:0xf
    v_add_f32_dpp v40, v76, v76 quad_perm:[1,0,3,2] row_mask:0xf bank_mask:0xf
    v_add_f32_dpp v41, v77, v77 quad_perm:[1,0,3,2] row_mask:0xf bank_mask:0xf
    v_add_f32_dpp v42, v78, v78 quad_perm:[1,0,3,2] row_mask:0xf bank_mask:0xf
    v_add_f32_dpp v43, v79, v79 quad_perm:[1,0,3,2] row_mask:0xf bank_mask:0xf
    v_add_f32_dpp v44, v80, v80 quad_perm:[1,0,3,2] row_mask:0xf bank_mask:0xf
    v_add_f32_dpp v45, v81, v81 quad_perm:[1,0,3,2] row_mask:0xf bank_mask:0xf
    v_add_f32_dpp v46, v82, v82 quad_perm:[1,0,3,2] row_mask:0xf bank_mask:0xf
    v_add_f32_dpp v47, v83, v83 quad_perm:[1,0,3,2] row_mask:0xf bank_mask:0xf
    v_cvt_pk_bf16_f32 v104, v28, v29
    v_cvt_pk_bf16_f32 v105, v30, v31
    v_cvt_pk_bf16_f32 v106, v32, v33
    v_cvt_pk_bf16_f32 v107, v34, v35
    v_cvt_pk_bf16_f32 v108, v36, v37
    v_cvt_pk_bf16_f32 v109, v38, v39
    v_cvt_pk_bf16_f32 v110, v40, v41
    v_cvt_pk_bf16_f32 v111, v42, v43
    v_cvt_pk_bf16_f32 v112, v44, v45
    v_cvt_pk_bf16_f32 v113, v46, v47
    s_nop 1
    v_mfma_f32_16x16x16_bf16 v[64:67], v[16:17], v[104:105], 0
    v_mfma_f32_16x16x16_bf16 v[68:71], v[16:17], v[106:107], 0
    v_mfma_f32_16x16x16_bf16 v[72:75], v[16:17], v[108:109], 0
    v_mfma_f32_16x16x16_bf16 v[76:79], v[16:17], v[110:111], 0
    v_mfma_f32_16x16x16_bf16 v[80:83], v[16:17], v[112:113], 0
    v_lshlrev_b32 v28, 16, v54
    v_and_b32 v29, s34, v54
    v_lshlrev_b32 v30, 16, v55
    v_and_b32 v31, s34, v55
    v_lshlrev_b32 v32, 16, v56
    v_and_b32 v33, s34, v56
    v_lshlrev_b32 v34, 16, v57
    v_and_b32 v35, s34, v57
    v_lshlrev_b32 v36, 16, v58
    v_and_b32 v37, s34, v58
    v_lshlrev_b32 v38, 16, v59
    v_and_b32 v39, s34, v59
    v_lshlrev_b32 v40, 16, v60
    v_and_b32 v41, s34, v60
    v_lshlrev_b32 v42, 16, v61
    v_and_b32 v43, s34, v61
    v_lshlrev_b32 v44, 16, v62
    v_and_b32 v45, s34, v62
    v_lshlrev_b32 v46, 16, v63
    v_and_b32 v47, s34, v63
    v_pk_fma_f32 v[28:29], v[64:65], v[84:85], v[28:29]
    v_pk_fma_f32 v[30:31], v[66:67], v[86:87], v[30:31]
    v_pk_fma_f32 v[32:33], v[68:69], v[88:89], v[32:33]
    v_pk_fma_f32 v[34:35], v[70:71], v[90:91], v[34:35]
    v_pk_fma_f32 v[36:37], v[72:73], v[92:93], v[36:37]
    v_pk_fma_f32 v[38:39], v[74:75], v[94:95], v[38:39]
    v_pk_fma_f32 v[40:41], v[76:77], v[96:97], v[40:41]
    v_pk_fma_f32 v[42:43], v[78:79], v[98:99], v[42:43]
    v_pk_fma_f32 v[44:45], v[80:81], v[100:101], v[44:45]
    v_pk_fma_f32 v[46:47], v[82:83], v[102:103], v[46:47]
    v_cvt_pk_bf16_f32 v104, v28, v29
    v_cvt_pk_bf16_f32 v105, v30, v31
    v_cvt_pk_bf16_f32 v106, v32, v33
    v_cvt_pk_bf16_f32 v107, v34, v35
    v_cvt_pk_bf16_f32 v108, v36, v37
    v_cvt_pk_bf16_f32 v109, v38, v39
    v_cvt_pk_bf16_f32 v110, v40, v41
    v_cvt_pk_bf16_f32 v111, v42, v43
    v_cvt_pk_bf16_f32 v112, v44, v45
    v_cvt_pk_bf16_f32 v113, v46, v47
    s_mov_b32 exec_lo, 0x55555555
    s_mov_b32 exec_hi, 0x55555555
    buffer_store_dwordx2 v[104:105], v52, s[16:19], s32 offen offset:0 sc1
    buffer_store_dwordx2 v[106:107], v52, s[16:19], s32 offen offset:256 sc1
    buffer_store_dwordx2 v[108:109], v52, s[16:19], s32 offen offset:512 sc1
    buffer_store_dwordx2 v[110:111], v52, s[16:19], s32 offen offset:768 sc1
    buffer_store_dwordx2 v[112:113], v52, s[16:19], s32 offen offset:1024 sc1
    s_mov_b64 exec, -1
    s_cmp_lg_u32 s2, 0
    s_cbranch_scc1 K_nog
    s_cmp_lg_u32 s3, 0
    s_cbranch_scc1 K_nog
    v_mov_b32 v114, s25
    s_mov_b64 exec, 1
    buffer_store_dword v114, v7, s[8:11], 0 offen offset:0
    s_mov_b64 exec, -1
K_nog:
    s_branch K_end
K_skip_0:
    s_mov_b64 exec, 1
    buffer_load_dwordx4 v[64:67], v7, s[12:15], s37 offen
    s_mov_b64 exec, -1
    v_add_u32 v114, s41, v53
    v_cmpx_le_u32 vcc, s46, v114
    v_add_u32 v114, s51, v114
    v_cmpx_le_u32 vcc, s56, v114
    v_add_u32 v114, s61, v114
    v_cmpx_le_u32 vcc, s66, v114
    v_mov_b32 v114, 2592
    s_mov_b64 exec, -1
    ds_read_b64 v[112:113], v114
    s_branch K_blk_1
K_skip_1:
    s_mov_b64 exec, 1
    buffer_load_dwordx4 v[68:71], v7, s[12:15], s37 offen
    s_mov_b64 exec, -1
    v_add_u32 v114, s42, v53
    v_cmpx_le_u32 vcc, s47, v114
    v_add_u32 v114, s52, v114
    v_cmpx_le_u32 vcc, s57, v114
    v_add_u32 v114, s62, v114
    v_cmpx_le_u32 vcc, s67, v114
    v_mov_b32 v114, 2592
    s_mov_b64 exec, -1
    ds_read_b64 v[112:113], v114
    s_branch K_blk_2
K_skip_2:
    s_mov_b64 exec, 1
    buffer_load_dwordx4 v[72:75], v7, s[12:15], s37 offen
    s_mov_b64 exec, -1
    v_add_u32 v114, s43, v53
    v_cmpx_le_u32 vcc, s48, v114
    v_add_u32 v114, s53, v114
    v_cmpx_le_u32 vcc, s58, v114
    v_add_u32 v114, s63, v114
    v_cmpx_le_u32 vcc, s68, v114
    v_mov_b32 v114, 2592
    s_mov_b64 exec, -1
    ds_read_b64 v[112:113], v114
    s_branch K_blk_3
K_skip_3:
    s_mov_b64 exec, 1
    buffer_load_dwordx4 v[76:79], v7, s[12:15], s37 offen
    s_mov_b64 exec, -1
    v_add_u32 v114, s44, v53
    v_cmpx_le_u32 vcc, s49, v114
    v_add_u32 v114, s54, v114
    v_cmpx_le_u32 vcc, s59, v114
    v_add_u32 v114, s64, v114
    v_cmpx_le_u32 vcc, s69, v114
    v_mov_b32 v114, 2592
    s_mov_b64 exec, -1
    ds_read_b64 v[112:113], v114
    s_branch K_blk_4
K_skip_4:
    s_mov_b64 exec, 1
    buffer_load_dwordx4 v[80:83], v7, s[12:15], s37 offen
    s_mov_b64 exec, -1
    v_add_u32 v53, 256, v53
    v_add_u32 v114, s40, v53
    v_cmpx_le_u32 vcc, s45, v114
    v_add_u32 v114, s50, v114
    v_cmpx_le_u32 vcc, s55, v114
    v_add_u32 v114, s60, v114
    v_cmpx_le_u32 vcc, s65, v114
    v_mov_b32 v114, 2592
    s_mov_b64 exec, -1
    ds_read_b64 v[112:113], v114
    s_branch K_stepend
K_end:
    s_endpgm
.section .rodata,"a"
.p2align 6
.amdhsa_kernel standalone__molecular_angular_gemnet__graph_kernel
  .amdhsa_next_free_vgpr 128
  .amdhsa_next_free_sgpr 102
  .amdhsa_accum_offset 128
  .amdhsa_group_segment_fixed_size 0
  .amdhsa_kernarg_size 112
  .amdhsa_user_sgpr_count 2
  .amdhsa_user_sgpr_kernarg_segment_ptr 1
  .amdhsa_system_sgpr_workgroup_id_x 1
.end_amdhsa_kernel
```
